```python
import torch

def _softmax(x, axis=-1):
    return torch.softmax(x, dim=axis)
def _gelu(x):
    return torch.nn.functional.gelu(x, approximate="tanh")
def _silu(x):
    return torch.nn.functional.silu(x)
def _sigmoid(x):
    return torch.sigmoid(x)
def _layernorm(x, axis=-1, eps=1e-5):
    m = x.mean(dim=axis, keepdim=True)
    v = x.var(dim=axis, keepdim=True, unbiased=False)
    return (x - m) / torch.sqrt(v + eps)
def _scatter_add(tgt, idx, src, axis=0):
    return tgt.clone().index_add_(axis, idx, src)
def _segment_sum(src, seg, n):
    out = torch.zeros((n,) + src.shape[1:], dtype=src.dtype)
    return out.index_add_(0, seg, src)
def _pad(x, pw):
    flat = tuple(v for pair in reversed(pw) for v in pair)
    return torch.nn.functional.pad(x, flat)

kernel_name = 'parallel_sum__grouped_kv_mqa__moe_arch_mod__prompt'

def setup_inputs():

    _w = (lambda a: (lambda t: t.to(torch.bfloat16) if t.is_floating_point() else t)(torch.as_tensor(a)))
    def _A_setup():
        B, S, D, H = 1, 2048, 512, 32
        Dh = D // H
        return {
            "x": _w((lambda *s: torch.randn(*s, dtype=torch.bfloat16) * 0.05)(B, S, D)),
            "wq": _w((lambda *s: torch.randn(*s, dtype=torch.bfloat16) * 0.2)(D, H * Dh)),
            "wk": _w((lambda *s: torch.randn(*s, dtype=torch.bfloat16) * 0.2)(D, Dh)),
            "wv": _w((lambda *s: torch.randn(*s, dtype=torch.bfloat16) * 0.1)(D, Dh)),
            "wo": _w((lambda *s: torch.randn(*s, dtype=torch.bfloat16) * 0.1)(H * Dh, D)),
        }
    _A_in = _A_setup()

    def _B_setup():
        B, S, D, F, C = 1, 2048, 512, 1376, 2
        return {
            "x": _w((lambda *s: torch.randn(*s, dtype=torch.bfloat16) * 0.05)(B, S, D)),
            "w_r": _w((lambda *s: torch.randn(*s, dtype=torch.bfloat16) * 0.2)(D)),
            "w_gate": _w((lambda *s: torch.randn(*s, dtype=torch.bfloat16) * 0.1)(D, F)),
            "w_up": _w((lambda *s: torch.randn(*s, dtype=torch.bfloat16) * 0.1)(D, F)),
            "w_down": _w((lambda *s: torch.randn(*s, dtype=torch.bfloat16) * 0.1)(F, D)),
        }
    _B_in = _B_setup()

    return {
        "A_x": _A_in["x"],
        "A_wq": _A_in["wq"],
        "A_wk": _A_in["wk"],
        "A_wv": _A_in["wv"],
        "A_wo": _A_in["wo"],
        "B_x": _B_in["x"],
        "B_w_r": _B_in["w_r"],
        "B_w_gate": _B_in["w_gate"],
        "B_w_up": _B_in["w_up"],
        "B_w_down": _B_in["w_down"],
    }

def reference(A_x, A_wq, A_wk, A_wv, A_wo, B_x, B_w_r, B_w_gate, B_w_up, B_w_down):
    def _A_ref(x, wq, wk, wv, wo):
        B, S, D = x.shape
        H = 32
        Dh = D // H
        q = (lambda x, *d: x.permute(*d))((x @ wq).reshape(B, S, H, Dh), 0, 2, 1, 3)
        k = x @ wk
        v = x @ wv
        scores = torch.einsum("bhqd,bkd->bhqk", q, k) * (Dh ** -0.5)
        p = _softmax(scores, axis=-1)
        o = torch.einsum("bhqk,bkd->bhqd", p, v)
        return (lambda x, *d: x.permute(*d))(o, 0, 2, 1, 3).reshape(B, S, H * Dh) @ wo

    def _B_ref(x, w_r, w_gate, w_up, w_down):
        B, S, D = x.shape
        C = 2
        r = x @ w_r
        idx = torch.argsort(-r, axis=-1)[:, :C]
        idx_e = (lambda x, n, axis: torch.repeat_interleave(x, n, dim=axis))(idx.reshape(B, C, 1), D, axis=2)
        x_sel = (lambda x, i, axis: torch.take_along_dim(x, i, dim=axis))(x, idx_e, axis=1)
        g = _silu(x_sel @ w_gate)
        u = x_sel @ w_up
        y = (g * u) @ w_down
        r_sel = _sigmoid((lambda x, i, axis: torch.take_along_dim(x, i, dim=axis))(r, idx, axis=1))
        y = y * r_sel.reshape(B, C, 1)
        b_off = (torch.arange(B) * S).reshape(B, 1)
        flat_idx = (idx + b_off).reshape(B * C)
        zero = (x * 0.0).reshape(B * S, D)
        upd = _scatter_add(zero, flat_idx, y.reshape(B * C, D), axis=0)
        return x + upd.reshape(B, S, D)

    x = A_x
    xn = _layernorm(x, axis=-1)
    return x + _A_ref(xn, A_wq, A_wk, A_wv, A_wo) + _B_ref(xn, B_w_r, B_w_gate, B_w_up, B_w_down)
```

```asm
; @launch kernel=k1_kernel grid=(256,1,1) block=(512,1,1) lds=99072
; @launch kernel=k2_kernel grid=(256,1,1) block=(512,1,1) lds=155648
.amdgcn_target "amdgcn-amd-amdhsa--gfx950"
.text
.globl k1_kernel
.p2align 8
.type k1_kernel,@function
k1_kernel:
    s_cmp_ge_u32 s2, 256
    s_cbranch_scc1 K1_END
    s_load_dwordx16 s[36:51], s[0:1], 0
    s_load_dwordx8 s[52:59], s[0:1], 64
    s_load_dwordx2 s[60:61], s[0:1], 96
    v_mov_b32 v58, 98816
    v_mov_b32 v59, 0
    ds_write_b32 v58, v59
    s_waitcnt lgkmcnt(0)
    s_mov_b32 s4, s36
    s_and_b32 s5, s37, 0xffff
    s_mov_b32 s6, 0x200000
    s_mov_b32 s7, 0x20000
    s_and_b32 s24, s2, 63
    s_lshr_b32 s25, s2, 6
    s_lshl_b32 s26, s24, 15
    v_lshrrev_b32 v1, 5, v0
    v_and_b32 v2, 31, v0
    v_lshlrev_b32 v3, 10, v1
    v_lshl_add_u32 v3, v2, 5, v3
    s_add_u32 s33, s26, 0
    buffer_load_dwordx4 v[96:99], v3, s[4:7], s33 offen
    buffer_load_dwordx4 v[100:103], v3, s[4:7], s33 offen offset:16
    s_add_u32 s33, s26, 16384
    buffer_load_dwordx4 v[104:107], v3, s[4:7], s33 offen
    buffer_load_dwordx4 v[108:111], v3, s[4:7], s33 offen offset:16
    s_mov_b32 s20, s48
    s_and_b32 s21, s49, 0xffff
    s_mov_b32 s22, 0x400
    s_mov_b32 s23, 0x20000
    v_lshlrev_b32 v4, 5, v2
    buffer_load_dwordx4 v[48:51], v4, s[20:23], 0 offen
    buffer_load_dwordx4 v[52:55], v4, s[20:23], 0 offen offset:16
    s_barrier
    v_and_b32 v232, 63, v0
    v_lshrrev_b32 v233, 6, v0
    s_nop 1
    v_readfirstlane_b32 s30, v233
    v_lshrrev_b32 v234, 2, v232
    v_and_b32 v235, 3, v232
    s_and_b32 s28, s30, 3
    s_lshr_b32 s29, s30, 2
    s_lshl_b32 s31, s25, 8
    s_lshl_b32 s33, s28, 6
    s_add_u32 s31, s31, s33
    s_lshl_b32 s33, s29, 18
    s_add_u32 s33, s33, s31
    v_lshlrev_b32 v236, 10, v234
    v_lshl_add_u32 v236, v235, 4, v236
    v_add_u32 v236, s33, v236
    v_mov_b32 v237, s39
    v_add_co_u32 v230, vcc, s38, v236
    v_addc_co_u32 v231, vcc, 0, v237, vcc
    global_load_dwordx4 v[160:163], v[230:231], off
    v_add_co_u32 v230, vcc, 16384, v230
    v_addc_co_u32 v231, vcc, 0, v231, vcc
    global_load_dwordx4 v[164:167], v[230:231], off
    v_add_co_u32 v230, vcc, 16384, v230
    v_addc_co_u32 v231, vcc, 0, v231, vcc
    global_load_dwordx4 v[168:171], v[230:231], off
    v_add_co_u32 v230, vcc, 16384, v230
    v_addc_co_u32 v231, vcc, 0, v231, vcc
    global_load_dwordx4 v[172:175], v[230:231], off
    v_add_co_u32 v230, vcc, 16384, v230
    v_addc_co_u32 v231, vcc, 0, v231, vcc
    global_load_dwordx4 v[176:179], v[230:231], off
    v_add_co_u32 v230, vcc, 16384, v230
    v_addc_co_u32 v231, vcc, 0, v231, vcc
    global_load_dwordx4 v[180:183], v[230:231], off
    v_add_co_u32 v230, vcc, 16384, v230
    v_addc_co_u32 v231, vcc, 0, v231, vcc
    global_load_dwordx4 v[184:187], v[230:231], off
    v_add_co_u32 v230, vcc, 16384, v230
    v_addc_co_u32 v231, vcc, 0, v231, vcc
    global_load_dwordx4 v[188:191], v[230:231], off
    v_add_co_u32 v230, vcc, 16384, v230
    v_addc_co_u32 v231, vcc, 0, v231, vcc
    global_load_dwordx4 v[192:195], v[230:231], off
    v_add_co_u32 v230, vcc, 16384, v230
    v_addc_co_u32 v231, vcc, 0, v231, vcc
    global_load_dwordx4 v[196:199], v[230:231], off
    v_add_co_u32 v230, vcc, 16384, v230
    v_addc_co_u32 v231, vcc, 0, v231, vcc
    global_load_dwordx4 v[200:203], v[230:231], off
    v_add_co_u32 v230, vcc, 16384, v230
    v_addc_co_u32 v231, vcc, 0, v231, vcc
    global_load_dwordx4 v[204:207], v[230:231], off
    v_add_co_u32 v230, vcc, 16384, v230
    v_addc_co_u32 v231, vcc, 0, v231, vcc
    global_load_dwordx4 v[208:211], v[230:231], off
    v_add_co_u32 v230, vcc, 16384, v230
    v_addc_co_u32 v231, vcc, 0, v231, vcc
    global_load_dwordx4 v[212:215], v[230:231], off
    v_add_co_u32 v230, vcc, 16384, v230
    v_addc_co_u32 v231, vcc, 0, v231, vcc
    global_load_dwordx4 v[216:219], v[230:231], off
    v_add_co_u32 v230, vcc, 16384, v230
    v_addc_co_u32 v231, vcc, 0, v231, vcc
    global_load_dwordx4 v[220:223], v[230:231], off
    v_add_co_u32 v230, vcc, 16384, v230
    v_addc_co_u32 v231, vcc, 0, v231, vcc
    s_lshl_b32 s33, s30, 11
    v_lshlrev_b32 v236, 5, v234
    v_and_b32 v237, 1, v235
    v_lshl_add_u32 v236, v237, 4, v236
    v_add_u32 v236, s33, v236
    v_cmp_lt_u32 vcc, 1, v235
    v_mov_b32 v237, s40
    v_mov_b32 v238, s42
    v_cndmask_b32 v237, v237, v238, vcc
    v_mov_b32 v238, s41
    v_mov_b32 v239, s43
    v_cndmask_b32 v238, v238, v239, vcc
    v_add_co_u32 v230, vcc, v237, v236
    v_addc_co_u32 v231, vcc, 0, v238, vcc
    global_load_dwordx4 v[128:131], v[230:231], off
    v_add_co_u32 v230, vcc, 512, v230
    v_addc_co_u32 v231, vcc, 0, v231, vcc
    global_load_dwordx4 v[132:135], v[230:231], off
    v_add_co_u32 v230, vcc, 512, v230
    v_addc_co_u32 v231, vcc, 0, v231, vcc
    global_load_dwordx4 v[136:139], v[230:231], off
    v_add_co_u32 v230, vcc, 512, v230
    v_addc_co_u32 v231, vcc, 0, v231, vcc
    global_load_dwordx4 v[140:143], v[230:231], off
    v_add_co_u32 v230, vcc, 512, v230
    v_addc_co_u32 v231, vcc, 0, v231, vcc
    v_and_b32 v26, 15, v0
    v_bfe_u32 v27, v0, 4, 2
    s_cmp_ge_u32 s2, 64
    s_cbranch_scc1 K1_R1
    s_mov_b32 s64, s44
    s_and_b32 s65, s45, 0xffff
    s_mov_b32 s66, 0x80000
    s_mov_b32 s67, 0x20000
    s_add_u32 s68, s60, 0x500000
    s_addc_u32 s69, s61, 0
    s_and_b32 s69, s69, 0xffff
    s_mov_b32 s70, 0x80000
    s_mov_b32 s71, 0x20000
    s_lshl_b32 s33, s2, 9
    v_add_u32 v25, s33, v0
    v_bfe_u32 v28, v25, 8, 4
    v_lshrrev_b32 v29, 12, v25
    v_bfe_u32 v30, v25, 6, 2
    v_lshl_add_u32 v29, v29, 2, v30
    s_branch K1_R2
K1_R1:
    s_mov_b32 s64, s54
    s_and_b32 s65, s55, 0xffff
    s_mov_b32 s66, 0x158000
    s_mov_b32 s67, 0x20000
    s_add_u32 s68, s60, 0x580000
    s_addc_u32 s69, s61, 0
    s_and_b32 s69, s69, 0xffff
    s_mov_b32 s70, 0x158000
    s_mov_b32 s71, 0x20000
    s_sub_u32 s33, s2, 64
    s_lshl_b32 s33, s33, 9
    v_add_u32 v25, s33, v0
    v_lshrrev_b32 v28, 11, v25
    v_bfe_u32 v29, v25, 6, 5
K1_R2:
    v_lshlrev_b32 v30, 15, v28
    v_lshl_add_u32 v30, v27, 13, v30
    v_lshl_add_u32 v30, v29, 5, v30
    v_lshl_add_u32 v30, v26, 1, v30
    v_lshlrev_b32 v24, 4, v25
    s_mov_b32 s8, s60
    s_and_b32 s9, s61, 0xffff
    s_mov_b32 s10, 0x200000
    s_mov_b32 s11, 0x20000
    s_add_u32 s12, s60, 0x200000
    s_addc_u32 s13, s61, 0
    s_and_b32 s13, s13, 0xffff
    s_mov_b32 s14, 0x200000
    s_mov_b32 s15, 0x20000
    s_add_u32 s16, s60, 0x400000
    s_addc_u32 s17, s61, 0
    s_and_b32 s17, s17, 0xffff
    s_mov_b32 s18, 0x30000
    s_mov_b32 s19, 0x20000
    v_and_b32 v236, 63, v0
    v_lshrrev_b32 v237, 6, v0
    v_lshlrev_b32 v237, 13, v237
    v_add_u32 v237, 33280, v237
    v_lshl_add_u32 v226, v236, 4, v237
    v_lshrrev_b32 v238, 5, v236
    v_lshlrev_b32 v238, 3, v238
    v_bfe_u32 v239, v236, 2, 2
    v_add_u32 v238, v238, v239
    v_lshlrev_b32 v238, 6, v238
    v_bfe_u32 v239, v236, 4, 1
    v_lshl_add_u32 v238, v239, 5, v238
    v_and_b32 v239, 3, v236
    v_lshl_add_u32 v238, v239, 3, v238
    v_add_u32 v228, v238, v237
    v_and_b32 v238, 31, v236
    v_mul_u32_u24 v238, 1040, v238
    v_lshrrev_b32 v239, 5, v236
    v_lshl_add_u32 v227, v239, 4, v238
    v_mul_u32_u24 v56, 1040, v1
    v_lshl_add_u32 v56, v2, 5, v56
    v_lshlrev_b32 v57, 2, v1
    s_mov_b32 s34, s26
    s_mov_b32 s35, 0
    s_lshl_b32 s27, s24, 7
    s_add_u32 s27, s27, 0x20000
    s_waitcnt vmcnt(20)
K1_LN:
    v_lshlrev_b32 v64, 16, v96
    v_and_b32 v65, 0xffff0000, v96
    v_lshlrev_b32 v66, 16, v97
    v_and_b32 v67, 0xffff0000, v97
    v_lshlrev_b32 v68, 16, v98
    v_and_b32 v69, 0xffff0000, v98
    v_lshlrev_b32 v70, 16, v99
    v_and_b32 v71, 0xffff0000, v99
    v_lshlrev_b32 v72, 16, v100
    v_and_b32 v73, 0xffff0000, v100
    v_lshlrev_b32 v74, 16, v101
    v_and_b32 v75, 0xffff0000, v101
    v_lshlrev_b32 v76, 16, v102
    v_and_b32 v77, 0xffff0000, v102
    v_lshlrev_b32 v78, 16, v103
    v_and_b32 v79, 0xffff0000, v103
    v_pk_add_f32 v[80:81], v[64:65], v[66:67]
    v_pk_add_f32 v[82:83], v[68:69], v[70:71]
    v_pk_add_f32 v[84:85], v[72:73], v[74:75]
    v_pk_add_f32 v[86:87], v[76:77], v[78:79]
    v_pk_add_f32 v[80:81], v[80:81], v[82:83]
    v_pk_add_f32 v[84:85], v[84:85], v[86:87]
    v_pk_add_f32 v[80:81], v[80:81], v[84:85]
    v_add_f32 v4, v80, v81
    s_nop 1
    v_add_f32_dpp v6, v4, v4 quad_perm:[1,0,3,2] row_mask:0xf bank_mask:0xf
    s_nop 1
    v_add_f32_dpp v4, v6, v6 quad_perm:[2,3,0,1] row_mask:0xf bank_mask:0xf
    s_nop 1
    v_add_f32_dpp v6, v4, v4 row_half_mirror row_mask:0xf bank_mask:0xf
    s_nop 1
    v_mov_b32 v4, v6
    s_nop 1
    v_add_f32_dpp v6, v4, v4 row_mirror row_mask:0xf bank_mask:0xf
    s_nop 1
    ds_swizzle_b32 v4, v6 offset:0x401F
    s_waitcnt lgkmcnt(0)
    v_add_f32 v4, v4, v6
    v_mul_f32 v4, 0x3b000000, v4
    v_pk_add_f32 v[80:81], v[64:65], v[4:5] op_sel_hi:[1,0] neg_lo:[0,1] neg_hi:[0,1]
    v_pk_add_f32 v[82:83], v[66:67], v[4:5] op_sel_hi:[1,0] neg_lo:[0,1] neg_hi:[0,1]
    v_pk_add_f32 v[84:85], v[68:69], v[4:5] op_sel_hi:[1,0] neg_lo:[0,1] neg_hi:[0,1]
    v_pk_add_f32 v[86:87], v[70:71], v[4:5] op_sel_hi:[1,0] neg_lo:[0,1] neg_hi:[0,1]
    v_pk_add_f32 v[88:89], v[72:73], v[4:5] op_sel_hi:[1,0] neg_lo:[0,1] neg_hi:[0,1]
    v_pk_add_f32 v[90:91], v[74:75], v[4:5] op_sel_hi:[1,0] neg_lo:[0,1] neg_hi:[0,1]
    v_pk_add_f32 v[92:93], v[76:77], v[4:5] op_sel_hi:[1,0] neg_lo:[0,1] neg_hi:[0,1]
    v_pk_add_f32 v[94:95], v[78:79], v[4:5] op_sel_hi:[1,0] neg_lo:[0,1] neg_hi:[0,1]
    v_pk_mul_f32 v[6:7], v[80:81], v[80:81]
    v_pk_mul_f32 v[8:9], v[82:83], v[82:83]
    v_pk_fma_f32 v[6:7], v[84:85], v[84:85], v[6:7]
    v_pk_fma_f32 v[8:9], v[86:87], v[86:87], v[8:9]
    v_pk_fma_f32 v[6:7], v[88:89], v[88:89], v[6:7]
    v_pk_fma_f32 v[8:9], v[90:91], v[90:91], v[8:9]
    v_pk_fma_f32 v[6:7], v[92:93], v[92:93], v[6:7]
    v_pk_fma_f32 v[8:9], v[94:95], v[94:95], v[8:9]
    v_pk_add_f32 v[6:7], v[6:7], v[8:9]
    v_add_f32 v6, v6, v7
    s_nop 1
    v_add_f32_dpp v8, v6, v6 quad_perm:[1,0,3,2] row_mask:0xf bank_mask:0xf
    s_nop 1
    v_add_f32_dpp v6, v8, v8 quad_perm:[2,3,0,1] row_mask:0xf bank_mask:0xf
    s_nop 1
    v_add_f32_dpp v8, v6, v6 row_half_mirror row_mask:0xf bank_mask:0xf
    s_nop 1
    v_mov_b32 v6, v8
    s_nop 1
    v_add_f32_dpp v8, v6, v6 row_mirror row_mask:0xf bank_mask:0xf
    s_nop 1
    ds_swizzle_b32 v6, v8 offset:0x401F
    s_waitcnt lgkmcnt(0)
    v_add_f32 v6, v6, v8
    v_mul_f32 v6, 0x3b000000, v6
    v_cvt_pk_bf16_f32 v4, 0, v4
    v_cvt_pk_bf16_f32 v6, 0, v6
    v_add_f32 v6, 0x3727c5ac, v6
    v_cvt_pk_bf16_f32 v6, 0, v6
    v_sqrt_f32 v6, v6
    s_nop 1
    v_cvt_pk_bf16_f32 v6, 0, v6
    v_rcp_f32 v8, v6
    v_pk_add_f32 v[64:65], v[64:65], v[4:5] op_sel_hi:[1,0] neg_lo:[0,1] neg_hi:[0,1]
    v_pk_add_f32 v[66:67], v[66:67], v[4:5] op_sel_hi:[1,0] neg_lo:[0,1] neg_hi:[0,1]
    v_pk_add_f32 v[68:69], v[68:69], v[4:5] op_sel_hi:[1,0] neg_lo:[0,1] neg_hi:[0,1]
    v_pk_add_f32 v[70:71], v[70:71], v[4:5] op_sel_hi:[1,0] neg_lo:[0,1] neg_hi:[0,1]
    v_pk_add_f32 v[72:73], v[72:73], v[4:5] op_sel_hi:[1,0] neg_lo:[0,1] neg_hi:[0,1]
    v_pk_add_f32 v[74:75], v[74:75], v[4:5] op_sel_hi:[1,0] neg_lo:[0,1] neg_hi:[0,1]
    v_pk_add_f32 v[76:77], v[76:77], v[4:5] op_sel_hi:[1,0] neg_lo:[0,1] neg_hi:[0,1]
    v_pk_add_f32 v[78:79], v[78:79], v[4:5] op_sel_hi:[1,0] neg_lo:[0,1] neg_hi:[0,1]
    v_cvt_pk_bf16_f32 v64, 0, v64
    v_cvt_pk_bf16_f32 v65, 0, v65
    v_cvt_pk_bf16_f32 v66, 0, v66
    v_cvt_pk_bf16_f32 v67, 0, v67
    v_cvt_pk_bf16_f32 v68, 0, v68
    v_cvt_pk_bf16_f32 v69, 0, v69
    v_cvt_pk_bf16_f32 v70, 0, v70
    v_cvt_pk_bf16_f32 v71, 0, v71
    v_cvt_pk_bf16_f32 v72, 0, v72
    v_cvt_pk_bf16_f32 v73, 0, v73
    v_cvt_pk_bf16_f32 v74, 0, v74
    v_cvt_pk_bf16_f32 v75, 0, v75
    v_cvt_pk_bf16_f32 v76, 0, v76
    v_cvt_pk_bf16_f32 v77, 0, v77
    v_cvt_pk_bf16_f32 v78, 0, v78
    v_cvt_pk_bf16_f32 v79, 0, v79
    v_pk_mul_f32 v[80:81], v[64:65], v[8:9] op_sel_hi:[1,0]
    v_pk_mul_f32 v[82:83], v[66:67], v[8:9] op_sel_hi:[1,0]
    v_pk_mul_f32 v[84:85], v[68:69], v[8:9] op_sel_hi:[1,0]
    v_pk_mul_f32 v[86:87], v[70:71], v[8:9] op_sel_hi:[1,0]
    v_pk_mul_f32 v[88:89], v[72:73], v[8:9] op_sel_hi:[1,0]
    v_pk_mul_f32 v[90:91], v[74:75], v[8:9] op_sel_hi:[1,0]
    v_pk_mul_f32 v[92:93], v[76:77], v[8:9] op_sel_hi:[1,0]
    v_pk_mul_f32 v[94:95], v[78:79], v[8:9] op_sel_hi:[1,0]
    v_pk_fma_f32 v[64:65], v[80:81], v[6:7], v[64:65] op_sel_hi:[1,0,1] neg_lo:[1,0,0] neg_hi:[1,0,0]
    v_pk_fma_f32 v[66:67], v[82:83], v[6:7], v[66:67] op_sel_hi:[1,0,1] neg_lo:[1,0,0] neg_hi:[1,0,0]
    v_pk_fma_f32 v[68:69], v[84:85], v[6:7], v[68:69] op_sel_hi:[1,0,1] neg_lo:[1,0,0] neg_hi:[1,0,0]
    v_pk_fma_f32 v[70:71], v[86:87], v[6:7], v[70:71] op_sel_hi:[1,0,1] neg_lo:[1,0,0] neg_hi:[1,0,0]
    v_pk_fma_f32 v[72:73], v[88:89], v[6:7], v[72:73] op_sel_hi:[1,0,1] neg_lo:[1,0,0] neg_hi:[1,0,0]
    v_pk_fma_f32 v[74:75], v[90:91], v[6:7], v[74:75] op_sel_hi:[1,0,1] neg_lo:[1,0,0] neg_hi:[1,0,0]
    v_pk_fma_f32 v[76:77], v[92:93], v[6:7], v[76:77] op_sel_hi:[1,0,1] neg_lo:[1,0,0] neg_hi:[1,0,0]
    v_pk_fma_f32 v[78:79], v[94:95], v[6:7], v[78:79] op_sel_hi:[1,0,1] neg_lo:[1,0,0] neg_hi:[1,0,0]
    v_pk_fma_f32 v[64:65], v[64:65], v[8:9], v[80:81] op_sel_hi:[1,0,1]
    v_pk_fma_f32 v[66:67], v[66:67], v[8:9], v[82:83] op_sel_hi:[1,0,1]
    v_pk_fma_f32 v[68:69], v[68:69], v[8:9], v[84:85] op_sel_hi:[1,0,1]
    v_pk_fma_f32 v[70:71], v[70:71], v[8:9], v[86:87] op_sel_hi:[1,0,1]
    v_pk_fma_f32 v[72:73], v[72:73], v[8:9], v[88:89] op_sel_hi:[1,0,1]
    v_pk_fma_f32 v[74:75], v[74:75], v[8:9], v[90:91] op_sel_hi:[1,0,1]
    v_pk_fma_f32 v[76:77], v[76:77], v[8:9], v[92:93] op_sel_hi:[1,0,1]
    v_pk_fma_f32 v[78:79], v[78:79], v[8:9], v[94:95] op_sel_hi:[1,0,1]
    v_cvt_pk_bf16_f32 v8, v64, v65
    v_cvt_pk_bf16_f32 v9, v66, v67
    v_cvt_pk_bf16_f32 v10, v68, v69
    v_cvt_pk_bf16_f32 v11, v70, v71
    v_cvt_pk_bf16_f32 v12, v72, v73
    v_cvt_pk_bf16_f32 v13, v74, v75
    v_cvt_pk_bf16_f32 v14, v76, v77
    v_cvt_pk_bf16_f32 v15, v78, v79
    ds_write_b128 v56, v[8:11]
    ds_write_b128 v56, v[12:15] offset:16
    v_add_u32 v56, 16640, v56
    s_cmp_lg_u32 s25, 0
    s_cbranch_scc1 K1_NOXN
    buffer_store_dwordx4 v[8:11], v3, s[8:11], s34 offen
    buffer_store_dwordx4 v[12:15], v3, s[8:11], s34 offen offset:16
K1_NOXN:
    s_cmp_lg_u32 s25, 1
    s_cbranch_scc1 K1_NOR1
    v_mov_b32 v5, 0
    v_mov_b32 v6, 0
    v_dot2_f32_bf16 v5, v8, v48, v5
    v_dot2_f32_bf16 v6, v9, v49, v6
    v_dot2_f32_bf16 v5, v10, v50, v5
    v_dot2_f32_bf16 v6, v11, v51, v6
    v_dot2_f32_bf16 v5, v12, v52, v5
    v_dot2_f32_bf16 v6, v13, v53, v6
    v_dot2_f32_bf16 v5, v14, v54, v5
    v_dot2_f32_bf16 v6, v15, v55, v6
    s_nop 3
    v_add_f32 v5, v5, v6
    s_nop 1
    v_add_f32_dpp v6, v5, v5 quad_perm:[1,0,3,2] row_mask:0xf bank_mask:0xf
    s_nop 1
    v_add_f32_dpp v5, v6, v6 quad_perm:[2,3,0,1] row_mask:0xf bank_mask:0xf
    s_nop 1
    v_add_f32_dpp v6, v5, v5 row_half_mirror row_mask:0xf bank_mask:0xf
    s_nop 1
    v_mov_b32 v5, v6
    s_nop 1
    v_add_f32_dpp v6, v5, v5 row_mirror row_mask:0xf bank_mask:0xf
    s_nop 1
    ds_swizzle_b32 v5, v6 offset:0x401F
    s_waitcnt lgkmcnt(0)
    v_add_f32 v5, v5, v6
    v_cvt_pk_bf16_f32 v5, 0, v5
    v_cmp_eq_u32 vcc, 0, v2
    s_and_saveexec_b64 s[72:73], vcc
    buffer_store_dword v5, v57, s[16:19], s27 offen
    s_mov_b64 exec, s[72:73]
K1_NOR1:
    v_mov_b32 v96, v104
    v_mov_b32 v97, v105
    v_mov_b32 v98, v106
    v_mov_b32 v99, v107
    v_mov_b32 v100, v108
    v_mov_b32 v101, v109
    v_mov_b32 v102, v110
    v_mov_b32 v103, v111
    s_add_u32 s27, s27, 64
    s_add_u32 s34, s34, 16384
    s_add_u32 s35, s35, 1
    s_cmp_lt_u32 s35, 2
    s_cbranch_scc1 K1_LN
    v_mov_b32 v59, 1
    s_waitcnt lgkmcnt(0)
    s_mov_b64 exec, 1
    ds_add_u32 v58, v59
    s_mov_b64 exec, -1
    s_mov_b32 s33, 4096
    buffer_load_ushort v16, v30, s[64:67], 0 offen offset:0
    buffer_load_ushort v17, v30, s[64:67], 0 offen offset:1024
    buffer_load_ushort v18, v30, s[64:67], 0 offen offset:2048
    buffer_load_ushort v19, v30, s[64:67], 0 offen offset:3072
    buffer_load_ushort v20, v30, s[64:67], s33 offen offset:0
    buffer_load_ushort v21, v30, s[64:67], s33 offen offset:1024
    buffer_load_ushort v22, v30, s[64:67], s33 offen offset:2048
    buffer_load_ushort v23, v30, s[64:67], s33 offen offset:3072
    s_cmp_lg_u32 s25, 0
    s_cbranch_scc1 K1_W1
    s_waitcnt vmcnt(12)
    s_branch K1_W3
K1_W1:
    s_cmp_lg_u32 s25, 1
    s_cbranch_scc1 K1_W2
    s_waitcnt vmcnt(10)
    s_branch K1_W3
K1_W2:
    s_waitcnt vmcnt(8)
K1_W3:
    ds_write_b128 v226, v[160:163] offset:0
    ds_write_b128 v226, v[164:167] offset:1024
    ds_write_b128 v226, v[168:171] offset:2048
    ds_write_b128 v226, v[172:175] offset:3072
    ds_read_b64_tr_b16 v[160:161], v228 offset:0
    ds_read_b64_tr_b16 v[162:163], v228 offset:256
    ds_read_b64_tr_b16 v[164:165], v228 offset:1024
    ds_read_b64_tr_b16 v[166:167], v228 offset:1280
    ds_read_b64_tr_b16 v[168:169], v228 offset:2048
    ds_read_b64_tr_b16 v[170:171], v228 offset:2304
    ds_read_b64_tr_b16 v[172:173], v228 offset:3072
    ds_read_b64_tr_b16 v[174:175], v228 offset:3328
    ds_write_b128 v226, v[176:179] offset:4096
    ds_write_b128 v226, v[180:183] offset:5120
    ds_write_b128 v226, v[184:187] offset:6144
    ds_write_b128 v226, v[188:191] offset:7168
    ds_read_b64_tr_b16 v[176:177], v228 offset:4096
    ds_read_b64_tr_b16 v[178:179], v228 offset:4352
    ds_read_b64_tr_b16 v[180:181], v228 offset:5120
    ds_read_b64_tr_b16 v[182:183], v228 offset:5376
    ds_read_b64_tr_b16 v[184:185], v228 offset:6144
    ds_read_b64_tr_b16 v[186:187], v228 offset:6400
    ds_read_b64_tr_b16 v[188:189], v228 offset:7168
    ds_read_b64_tr_b16 v[190:191], v228 offset:7424
    ds_write_b128 v226, v[192:195] offset:0
    ds_write_b128 v226, v[196:199] offset:1024
    ds_write_b128 v226, v[200:203] offset:2048
    ds_write_b128 v226, v[204:207] offset:3072
    ds_read_b64_tr_b16 v[192:193], v228 offset:0
    ds_read_b64_tr_b16 v[194:195], v228 offset:256
    ds_read_b64_tr_b16 v[196:197], v228 offset:1024
    ds_read_b64_tr_b16 v[198:199], v228 offset:1280
    ds_read_b64_tr_b16 v[200:201], v228 offset:2048
    ds_read_b64_tr_b16 v[202:203], v228 offset:2304
    ds_read_b64_tr_b16 v[204:205], v228 offset:3072
    ds_read_b64_tr_b16 v[206:207], v228 offset:3328
    ds_write_b128 v226, v[208:211] offset:4096
    ds_write_b128 v226, v[212:215] offset:5120
    ds_write_b128 v226, v[216:219] offset:6144
    ds_write_b128 v226, v[220:223] offset:7168
    ds_read_b64_tr_b16 v[208:209], v228 offset:4096
    ds_read_b64_tr_b16 v[210:211], v228 offset:4352
    ds_read_b64_tr_b16 v[212:213], v228 offset:5120
    ds_read_b64_tr_b16 v[214:215], v228 offset:5376
    ds_read_b64_tr_b16 v[216:217], v228 offset:6144
    ds_read_b64_tr_b16 v[218:219], v228 offset:6400
    ds_read_b64_tr_b16 v[220:221], v228 offset:7168
    ds_read_b64_tr_b16 v[222:223], v228 offset:7424
    s_cmp_lg_u32 s25, 3
    s_cbranch_scc1 K1_WAIT
    ds_write_b128 v226, v[128:131] offset:0
    ds_write_b128 v226, v[132:135] offset:1024
    ds_write_b128 v226, v[136:139] offset:2048
    ds_write_b128 v226, v[140:143] offset:3072
    ds_read_b64_tr_b16 v[128:129], v228 offset:0
    ds_read_b64_tr_b16 v[130:131], v228 offset:256
    ds_read_b64_tr_b16 v[132:133], v228 offset:1024
    ds_read_b64_tr_b16 v[134:135], v228 offset:1280
    ds_read_b64_tr_b16 v[136:137], v228 offset:2048
    ds_read_b64_tr_b16 v[138:139], v228 offset:2304
    ds_read_b64_tr_b16 v[140:141], v228 offset:3072
    ds_read_b64_tr_b16 v[142:143], v228 offset:3328
K1_WAIT:
    ds_read_b32 v59, v58
    s_waitcnt lgkmcnt(0)
    s_nop 1
    v_readfirstlane_b32 s33, v59
    s_cmp_lt_u32 s33, 8
    s_cbranch_scc1 K1_WAIT
    s_lshl_b32 s33, s29, 9
    v_add_u32 v229, s33, v227
    ds_read_b128 v[96:99], v229 offset:0
    ds_read_b128 v[100:103], v229 offset:32
    ds_read_b128 v[104:107], v229 offset:64
    ds_read_b128 v[108:111], v229 offset:96
    s_waitcnt lgkmcnt(3)
    v_mfma_f32_32x32x16_bf16 v[64:79], v[160:163], v[96:99], 0
    ds_read_b128 v[96:99], v229 offset:128
    s_waitcnt lgkmcnt(3)
    v_mfma_f32_32x32x16_bf16 v[64:79], v[164:167], v[100:103], v[64:79]
    ds_read_b128 v[100:103], v229 offset:160
    s_waitcnt lgkmcnt(3)
    v_mfma_f32_32x32x16_bf16 v[64:79], v[168:171], v[104:107], v[64:79]
    ds_read_b128 v[104:107], v229 offset:192
    s_waitcnt lgkmcnt(3)
    v_mfma_f32_32x32x16_bf16 v[64:79], v[172:175], v[108:111], v[64:79]
    ds_read_b128 v[108:111], v229 offset:224
    s_waitcnt lgkmcnt(3)
    v_mfma_f32_32x32x16_bf16 v[64:79], v[176:179], v[96:99], v[64:79]
    ds_read_b128 v[96:99], v229 offset:256
    s_waitcnt lgkmcnt(3)
    v_mfma_f32_32x32x16_bf16 v[64:79], v[180:183], v[100:103], v[64:79]
    ds_read_b128 v[100:103], v229 offset:288
    s_waitcnt lgkmcnt(3)
    v_mfma_f32_32x32x16_bf16 v[64:79], v[184:187], v[104:107], v[64:79]
    ds_read_b128 v[104:107], v229 offset:320
    s_waitcnt lgkmcnt(3)
    v_mfma_f32_32x32x16_bf16 v[64:79], v[188:191], v[108:111], v[64:79]
    ds_read_b128 v[108:111], v229 offset:352
    s_waitcnt lgkmcnt(3)
    v_mfma_f32_32x32x16_bf16 v[64:79], v[192:195], v[96:99], v[64:79]
    ds_read_b128 v[96:99], v229 offset:384
    s_waitcnt lgkmcnt(3)
    v_mfma_f32_32x32x16_bf16 v[64:79], v[196:199], v[100:103], v[64:79]
    ds_read_b128 v[100:103], v229 offset:416
    s_waitcnt lgkmcnt(3)
    v_mfma_f32_32x32x16_bf16 v[64:79], v[200:203], v[104:107], v[64:79]
    ds_read_b128 v[104:107], v229 offset:448
    s_waitcnt lgkmcnt(3)
    v_mfma_f32_32x32x16_bf16 v[64:79], v[204:207], v[108:111], v[64:79]
    ds_read_b128 v[108:111], v229 offset:480
    s_waitcnt lgkmcnt(3)
    v_mfma_f32_32x32x16_bf16 v[64:79], v[208:211], v[96:99], v[64:79]
    s_waitcnt lgkmcnt(2)
    v_mfma_f32_32x32x16_bf16 v[64:79], v[212:215], v[100:103], v[64:79]
    s_waitcnt lgkmcnt(1)
    v_mfma_f32_32x32x16_bf16 v[64:79], v[216:219], v[104:107], v[64:79]
    s_waitcnt lgkmcnt(0)
    v_mfma_f32_32x32x16_bf16 v[64:79], v[220:223], v[108:111], v[64:79]
    s_cmp_lg_u32 s25, 3
    s_cbranch_scc1 K1_NOKV
    s_lshl_b32 s33, s30, 7
    v_add_u32 v229, s33, v227
    ds_read_b128 v[112:115], v229 offset:0
    ds_read_b128 v[116:119], v229 offset:32
    ds_read_b128 v[120:123], v229 offset:64
    ds_read_b128 v[124:127], v229 offset:96
    s_waitcnt lgkmcnt(3)
    v_mfma_f32_32x32x16_bf16 v[144:159], v[128:131], v[112:115], 0
    s_waitcnt lgkmcnt(2)
    v_mfma_f32_32x32x16_bf16 v[144:159], v[132:135], v[116:119], v[144:159]
    s_waitcnt lgkmcnt(1)
    v_mfma_f32_32x32x16_bf16 v[144:159], v[136:139], v[120:123], v[144:159]
    s_waitcnt lgkmcnt(0)
    v_mfma_f32_32x32x16_bf16 v[144:159], v[140:143], v[124:127], v[144:159]
    s_nop 7
    s_nop 7
    ds_write_b128 v226, v[144:147] offset:4096
    ds_write_b128 v226, v[148:151] offset:5120
    ds_write_b128 v226, v[152:155] offset:6144
    ds_write_b128 v226, v[156:159] offset:7168
K1_NOKV:
    s_nop 7
    s_nop 7
    s_cmp_eq_u32 s29, 0
    s_cbranch_scc1 K1_B2
    ds_write_b128 v226, v[64:67] offset:0
    ds_write_b128 v226, v[68:71] offset:1024
    ds_write_b128 v226, v[72:75] offset:2048
    ds_write_b128 v226, v[76:79] offset:3072
K1_B2:
    s_waitcnt lgkmcnt(0)
    s_barrier
    v_and_b32 v50, 31, v232
    v_lshrrev_b32 v51, 5, v232
    s_cmp_lg_u32 s29, 0
    s_cbranch_scc1 K1_NOQ
    ds_read_b128 v[80:83], v226 offset:32768
    ds_read_b128 v[84:87], v226 offset:33792
    ds_read_b128 v[88:91], v226 offset:34816
    ds_read_b128 v[92:95], v226 offset:35840
    v_lshlrev_b32 v52, 10, v50
    v_lshl_add_u32 v52, v51, 3, v52
    v_add_u32 v52, s31, v52
    s_waitcnt lgkmcnt(0)
    v_add_f32 v64, v64, v80
    v_add_f32 v65, v65, v81
    v_add_f32 v66, v66, v82
    v_add_f32 v67, v67, v83
    v_add_f32 v68, v68, v84
    v_add_f32 v69, v69, v85
    v_add_f32 v70, v70, v86
    v_add_f32 v71, v71, v87
    v_add_f32 v72, v72, v88
    v_add_f32 v73, v73, v89
    v_add_f32 v74, v74, v90
    v_add_f32 v75, v75, v91
    v_add_f32 v76, v76, v92
    v_add_f32 v77, v77, v93
    v_add_f32 v78, v78, v94
    v_add_f32 v79, v79, v95
    v_mul_f32 v64, 0x3eb8aa3b, v64
    v_mul_f32 v65, 0x3eb8aa3b, v65
    v_mul_f32 v66, 0x3eb8aa3b, v66
    v_mul_f32 v67, 0x3eb8aa3b, v67
    v_mul_f32 v68, 0x3eb8aa3b, v68
    v_mul_f32 v69, 0x3eb8aa3b, v69
    v_mul_f32 v70, 0x3eb8aa3b, v70
    v_mul_f32 v71, 0x3eb8aa3b, v71
    v_mul_f32 v72, 0x3eb8aa3b, v72
    v_mul_f32 v73, 0x3eb8aa3b, v73
    v_mul_f32 v74, 0x3eb8aa3b, v74
    v_mul_f32 v75, 0x3eb8aa3b, v75
    v_mul_f32 v76, 0x3eb8aa3b, v76
    v_mul_f32 v77, 0x3eb8aa3b, v77
    v_mul_f32 v78, 0x3eb8aa3b, v78
    v_mul_f32 v79, 0x3eb8aa3b, v79
    v_cvt_pk_bf16_f32 v56, v64, v65
    v_cvt_pk_bf16_f32 v57, v66, v67
    v_cvt_pk_bf16_f32 v58, v68, v69
    v_cvt_pk_bf16_f32 v59, v70, v71
    v_cvt_pk_bf16_f32 v60, v72, v73
    v_cvt_pk_bf16_f32 v61, v74, v75
    v_cvt_pk_bf16_f32 v62, v76, v77
    v_cvt_pk_bf16_f32 v63, v78, v79
    buffer_store_dwordx2 v[56:57], v52, s[12:15], s26 offen offset:0
    buffer_store_dwordx2 v[58:59], v52, s[12:15], s26 offen offset:16
    buffer_store_dwordx2 v[60:61], v52, s[12:15], s26 offen offset:32
    buffer_store_dwordx2 v[62:63], v52, s[12:15], s26 offen offset:48
K1_NOQ:
    s_cmp_lg_u32 s25, 3
    s_cbranch_scc1 K1_FIN
    s_lshr_b32 s33, s30, 1
    s_lshl_b32 s33, s33, 10
    s_and_b32 s34, s30, 1
    s_lshl_b32 s35, s34, 3
    s_add_u32 s33, s33, s35
    s_add_u32 s33, s33, 37376
    v_lshlrev_b32 v53, 4, v232
    v_add_u32 v53, s33, v53
    ds_read_b64 v[96:97], v53 offset:0
    ds_read_b64 v[98:99], v53 offset:8192
    ds_read_b64 v[100:101], v53 offset:16384
    ds_read_b64 v[102:103], v53 offset:24576
    ds_read_b64 v[104:105], v53 offset:32768
    ds_read_b64 v[106:107], v53 offset:40960
    ds_read_b64 v[108:109], v53 offset:49152
    ds_read_b64 v[110:111], v53 offset:57344
    s_lshl_b32 s27, s24, 10
    s_waitcnt lgkmcnt(0)
    v_add_f32 v96, v96, v98
    v_add_f32 v97, v97, v99
    v_add_f32 v96, v96, v100
    v_add_f32 v97, v97, v101
    v_add_f32 v96, v96, v102
    v_add_f32 v97, v97, v103
    v_add_f32 v96, v96, v104
    v_add_f32 v97, v97, v105
    v_add_f32 v96, v96, v106
    v_add_f32 v97, v97, v107
    v_add_f32 v96, v96, v108
    v_add_f32 v97, v97, v109
    v_add_f32 v96, v96, v110
    v_add_f32 v97, v97, v111
    v_cvt_pk_bf16_f32 v96, v96, v97
    s_cmp_ge_u32 s30, 4
    s_cbranch_scc1 K1_VOUT
    s_lshr_b32 s33, s30, 1
    s_lshl_b32 s33, s33, 9
    s_lshl_b32 s35, s34, 2
    s_add_u32 s33, s33, s35
    s_add_u32 s27, s27, s33
    v_lshlrev_b32 v52, 4, v50
    v_lshl_add_u32 v52, v51, 3, v52
    buffer_store_dword v96, v52, s[16:19], s27 offen
    s_branch K1_FIN
K1_VOUT:
    s_add_u32 s27, s27, 0x10000
    s_sub_u32 s33, s30, 4
    s_lshr_b32 s33, s33, 1
    s_lshl_b32 s33, s33, 7
    s_lshl_b32 s35, s34, 5
    s_add_u32 s33, s33, s35
    s_add_u32 s27, s27, s33
    v_lshrrev_b32 v52, 4, v50
    v_lshlrev_b32 v52, 9, v52
    v_bfe_u32 v53, v50, 2, 1
    v_lshl_add_u32 v52, v53, 8, v52
    v_bfe_u32 v53, v50, 3, 1
    v_lshl_add_u32 v52, v53, 3, v52
    v_and_b32 v53, 3, v50
    v_lshl_add_u32 v52, v53, 1, v52
    v_lshl_add_u32 v52, v51, 6, v52
    v_lshrrev_b32 v54, 16, v96
    buffer_store_short v96, v52, s[16:19], s27 offen
    buffer_store_short v54, v52, s[16:19], s27 offen offset:16
K1_FIN:
    s_cmp_ge_u32 s2, 236
    s_cbranch_scc1 K1_END
    s_waitcnt vmcnt(0)
    v_lshl_or_b32 v8, v17, 16, v16
    v_lshl_or_b32 v9, v19, 16, v18
    v_lshl_or_b32 v10, v21, 16, v20
    v_lshl_or_b32 v11, v23, 16, v22
    buffer_store_dwordx4 v[8:11], v24, s[68:71], 0 offen
    s_cmp_lg_u32 s2, 0
    s_cbranch_scc1 K1_END
    s_add_u32 s12, s60, 0x430000
    s_addc_u32 s13, s61, 0
    s_and_b32 s13, s13, 0xffff
    s_mov_b32 s14, 0x1000
    s_mov_b32 s15, 0x20000
    v_mov_b32 v16, 0
    v_mov_b32 v17, 0
    v_mov_b32 v18, 0
    v_mov_b32 v19, 0
    v_lshlrev_b32 v1, 4, v0
    v_cmp_gt_u32 vcc, 256, v0
    s_and_saveexec_b64 s[72:73], vcc
    buffer_store_dwordx4 v[16:19], v1, s[12:15], 0 offen sc1
K1_END:
    s_endpgm
.globl k2_kernel
.p2align 8
.type k2_kernel,@function
k2_kernel:
    s_cmp_ge_u32 s2, 256
    s_cbranch_scc1 K2_END
    s_load_dwordx16 s[36:51], s[0:1], 0
    s_load_dwordx8 s[52:59], s[0:1], 64
    s_load_dwordx2 s[60:61], s[0:1], 96
    s_waitcnt lgkmcnt(0)
    s_add_u32 s4, s60, 0x400000
    s_addc_u32 s5, s61, 0
    s_and_b32 s5, s5, 0xffff
    s_mov_b32 s6, 0x10000
    s_mov_b32 s7, 0x20000
    s_add_u32 s8, s60, 0x410000
    s_addc_u32 s9, s61, 0
    s_and_b32 s9, s9, 0xffff
    s_mov_b32 s10, 0x10000
    s_mov_b32 s11, 0x20000
    s_add_u32 s12, s60, 0x200000
    s_addc_u32 s13, s61, 0
    s_and_b32 s13, s13, 0xffff
    s_mov_b32 s14, 0x200000
    s_mov_b32 s15, 0x20000
    v_lshlrev_b32 v3, 4, v0
    s_mov_b32 s88, 0
    buffer_load_dwordx4 v[120:123], v3, s[4:7], s88 offen
    s_mov_b32 s88, 8192
    buffer_load_dwordx4 v[124:127], v3, s[4:7], s88 offen
    s_mov_b32 s88, 16384
    buffer_load_dwordx4 v[128:131], v3, s[4:7], s88 offen
    s_mov_b32 s88, 24576
    buffer_load_dwordx4 v[132:135], v3, s[4:7], s88 offen
    s_mov_b32 s88, 32768
    buffer_load_dwordx4 v[136:139], v3, s[4:7], s88 offen
    s_mov_b32 s88, 40960
    buffer_load_dwordx4 v[140:143], v3, s[4:7], s88 offen
    s_mov_b32 s88, 49152
    buffer_load_dwordx4 v[144:147], v3, s[4:7], s88 offen
    s_mov_b32 s88, 57344
    buffer_load_dwordx4 v[148:151], v3, s[4:7], s88 offen
    v_and_b32 v4, 63, v0
    v_lshrrev_b32 v5, 6, v0
    s_nop 1
    v_readfirstlane_b32 s84, v5
    v_lshlrev_b32 v1, 4, v4
    v_add_u32 v1, 24576, v1
    v_and_b32 v6, 31, v4
    v_lshrrev_b32 v7, 5, v4
    s_lshl_b32 s85, s2, 3
    s_add_u32 s85, s85, s84
    s_lshl_b32 s85, s85, 10
    v_lshlrev_b32 v2, 5, v6
    v_lshl_add_u32 v2, v7, 4, v2
    buffer_load_dwordx4 v[8:11], v2, s[12:15], s85 offen
    s_add_u32 s72, s60, 0x420000
    s_addc_u32 s73, s61, 0
    s_and_b32 s73, s73, 0xffff
    s_mov_b32 s74, 0x2000
    s_mov_b32 s75, 0x20000
    buffer_load_dwordx4 v[88:91], v3, s[72:75], 0 offen
    s_mov_b32 s88, 0
    buffer_load_dwordx4 v[152:155], v3, s[8:11], s88 offen
    s_mov_b32 s88, 8192
    buffer_load_dwordx4 v[156:159], v3, s[8:11], s88 offen
    s_mov_b32 s88, 16384
    buffer_load_dwordx4 v[160:163], v3, s[8:11], s88 offen
    s_mov_b32 s88, 24576
    buffer_load_dwordx4 v[164:167], v3, s[8:11], s88 offen
    s_mov_b32 s88, 32768
    buffer_load_dwordx4 v[168:171], v3, s[8:11], s88 offen
    s_mov_b32 s88, 40960
    buffer_load_dwordx4 v[172:175], v3, s[8:11], s88 offen
    s_mov_b32 s88, 49152
    buffer_load_dwordx4 v[176:179], v3, s[8:11], s88 offen
    s_mov_b32 s88, 57344
    buffer_load_dwordx4 v[180:183], v3, s[8:11], s88 offen
    v_lshlrev_b32 v2, 4, v6
    v_lshl_add_u32 v2, v7, 8, v2
    v_add_u32 v2, 90112, v2
    s_mov_b32 s86, 0xffff
    s_mov_b32 s87, 0xffff
    v_mov_b32 v12, 0
    v_mov_b32 v13, 0x3f803f80
    v_cmp_eq_u32 vcc, 16, v6
    s_nop 1
    v_cndmask_b32 v12, v12, v13, vcc
    v_mov_b32 v24, v12
    v_mov_b32 v25, v12
    v_mov_b32 v26, v12
    v_mov_b32 v27, v12
    v_mov_b32 v28, v12
    v_mov_b32 v29, v12
    v_mov_b32 v30, v12
    v_mov_b32 v31, v12
    v_mov_b32 v32, v12
    v_mov_b32 v33, v12
    v_mov_b32 v34, v12
    v_mov_b32 v35, v12
    v_mov_b32 v36, v12
    v_mov_b32 v37, v12
    v_mov_b32 v38, v12
    v_mov_b32 v39, v12
    s_mov_b32 s16, s50
    s_and_b32 s17, s51, 0xffff
    s_mov_b32 s18, 0x158000
    s_mov_b32 s19, 0x20000
    s_mov_b32 s20, s52
    s_and_b32 s21, s53, 0xffff
    s_mov_b32 s22, 0x158000
    s_mov_b32 s23, 0x20000
    s_add_u32 s24, s60, 0x580000
    s_addc_u32 s25, s61, 0
    s_and_b32 s25, s25, 0xffff
    s_mov_b32 s26, 0x158000
    s_mov_b32 s27, 0x20000
    s_mov_b32 s28, s60
    s_and_b32 s29, s61, 0xffff
    s_mov_b32 s30, 0x200000
    s_mov_b32 s31, 0x20000
    s_add_u32 s32, s60, 0x500000
    s_addc_u32 s33, s61, 0
    s_and_b32 s33, s33, 0xffff
    s_mov_b32 s34, 0x80000
    s_mov_b32 s35, 0x20000
    s_mov_b32 s64, s56
    s_and_b32 s65, s57, 0xffff
    s_mov_b32 s66, 0x200000
    s_mov_b32 s67, 0x20000
    s_mov_b32 s68, s36
    s_and_b32 s69, s37, 0xffff
    s_mov_b32 s70, 0x200000
    s_mov_b32 s71, 0x20000
    s_add_u32 s76, s60, 0x430000
    s_addc_u32 s77, s61, 0
    s_and_b32 s77, s77, 0xffff
    s_mov_b32 s78, 0x3000
    s_mov_b32 s79, 0x20000
    s_mov_b32 s80, s58
    s_and_b32 s81, s59, 0xffff
    s_mov_b32 s82, 0x100
    s_mov_b32 s83, 0x20000
    v_mov_b32 v56, 0xff800000
    v_mov_b32 v57, 0xff800000
    v_mov_b32 v58, 0xff800000
    v_mov_b32 v59, 0xff800000
    v_mov_b32 v60, 0xff800000
    v_mov_b32 v61, 0xff800000
    v_mov_b32 v62, 0xff800000
    v_mov_b32 v63, 0xff800000
    v_mov_b32 v64, 0xff800000
    v_mov_b32 v65, 0xff800000
    v_mov_b32 v66, 0xff800000
    v_mov_b32 v67, 0xff800000
    v_mov_b32 v68, 0xff800000
    v_mov_b32 v69, 0xff800000
    v_mov_b32 v70, 0xff800000
    v_mov_b32 v71, 0xff800000
    v_mov_b32 v100, 0xff800000
    v_mov_b32 v101, 0xff800000
    v_mov_b32 v102, 0xff800000
    v_mov_b32 v103, 0xff800000
    v_lshlrev_b32 v96, 2, v0
    v_sub_u32 v96, 2047, v96
    v_mov_b32 v92, 0
    v_mov_b32 v93, 0
    s_waitcnt vmcnt(8)
    v_ashrrev_i32 v97, 31, v88
    v_or_b32 v97, 0x80000000, v97
    v_xor_b32 v97, v97, v88
    v_and_b32 v97, 0xffff0000, v97
    v_subrev_u32 v98, 0, v96
    v_or_b32 v97, v97, v98
    v_min_u32 v98, v92, v97
    v_max_u32 v93, v93, v98
    v_max_u32 v92, v92, v97
    v_ashrrev_i32 v97, 31, v89
    v_or_b32 v97, 0x80000000, v97
    v_xor_b32 v97, v97, v89
    v_and_b32 v97, 0xffff0000, v97
    v_subrev_u32 v98, 1, v96
    v_or_b32 v97, v97, v98
    v_min_u32 v98, v92, v97
    v_max_u32 v93, v93, v98
    v_max_u32 v92, v92, v97
    v_ashrrev_i32 v97, 31, v90
    v_or_b32 v97, 0x80000000, v97
    v_xor_b32 v97, v97, v90
    v_and_b32 v97, 0xffff0000, v97
    v_subrev_u32 v98, 2, v96
    v_or_b32 v97, v97, v98
    v_min_u32 v98, v92, v97
    v_max_u32 v93, v93, v98
    v_max_u32 v92, v92, v97
    v_ashrrev_i32 v97, 31, v91
    v_or_b32 v97, 0x80000000, v97
    v_xor_b32 v97, v97, v91
    v_and_b32 v97, 0xffff0000, v97
    v_subrev_u32 v98, 3, v96
    v_or_b32 v97, v97, v98
    v_min_u32 v98, v92, v97
    v_max_u32 v93, v93, v98
    v_max_u32 v92, v92, v97
    v_add_u32 v3, 24576, v3
    ds_write_b128 v3, v[120:123] offset:0
    ds_write_b128 v3, v[124:127] offset:8192
    ds_write_b128 v3, v[128:131] offset:16384
    ds_write_b128 v3, v[132:135] offset:24576
    ds_write_b128 v3, v[136:139] offset:32768
    ds_write_b128 v3, v[140:143] offset:40960
    ds_write_b128 v3, v[144:147] offset:49152
    ds_write_b128 v3, v[148:151] offset:57344
    ds_swizzle_b32 v94, v92 offset:0x41f
    ds_swizzle_b32 v95, v93 offset:0x41f
    s_waitcnt lgkmcnt(0)
    v_min_u32 v97, v92, v94
    v_max_u32 v92, v92, v94
    v_max_u32 v93, v93, v95
    v_max_u32 v93, v93, v97
    ds_swizzle_b32 v94, v92 offset:0x81f
    ds_swizzle_b32 v95, v93 offset:0x81f
    s_waitcnt lgkmcnt(0)
    v_min_u32 v97, v92, v94
    v_max_u32 v92, v92, v94
    v_max_u32 v93, v93, v95
    v_max_u32 v93, v93, v97
    ds_swizzle_b32 v94, v92 offset:0x101f
    ds_swizzle_b32 v95, v93 offset:0x101f
    s_waitcnt lgkmcnt(0)
    v_min_u32 v97, v92, v94
    v_max_u32 v92, v92, v94
    v_max_u32 v93, v93, v95
    v_max_u32 v93, v93, v97
    ds_swizzle_b32 v94, v92 offset:0x201f
    ds_swizzle_b32 v95, v93 offset:0x201f
    s_waitcnt lgkmcnt(0)
    v_min_u32 v97, v92, v94
    v_max_u32 v92, v92, v94
    v_max_u32 v93, v93, v95
    v_max_u32 v93, v93, v97
    ds_swizzle_b32 v94, v92 offset:0x401f
    ds_swizzle_b32 v95, v93 offset:0x401f
    s_waitcnt lgkmcnt(0)
    v_min_u32 v97, v92, v94
    v_max_u32 v92, v92, v94
    v_max_u32 v93, v93, v95
    v_max_u32 v93, v93, v97
    v_xor_b32 v15, 32, v4
    v_lshlrev_b32 v15, 2, v15
    ds_bpermute_b32 v94, v15, v92
    ds_bpermute_b32 v95, v15, v93
    s_waitcnt lgkmcnt(0)
    v_min_u32 v97, v92, v94
    v_max_u32 v92, v92, v94
    v_max_u32 v93, v93, v95
    v_max_u32 v93, v93, v97
    v_lshlrev_b32 v12, 3, v5
    v_add_u32 v12, 16384, v12
    ds_write_b64 v12, v[92:93]
    s_waitcnt lgkmcnt(0)
    s_barrier
    ds_read_b128 v[72:75], v1 offset:0
    ds_read_b128 v[76:79], v1 offset:1024
    ds_read_b128 v[80:83], v1 offset:2048
    v_mov_b32 v12, 16384
    v_mov_b32 v92, 0
    v_mov_b32 v93, 0
    ds_read_b128 v[40:43], v12 offset:0
    ds_read_b128 v[44:47], v12 offset:16
    ds_read_b128 v[48:51], v12 offset:32
    ds_read_b128 v[52:55], v12 offset:48
    s_waitcnt lgkmcnt(0)
    v_mov_b32 v94, v40
    v_mov_b32 v95, v41
    v_min_u32 v97, v92, v94
    v_max_u32 v92, v92, v94
    v_max_u32 v93, v93, v95
    v_max_u32 v93, v93, v97
    v_mov_b32 v94, v42
    v_mov_b32 v95, v43
    v_min_u32 v97, v92, v94
    v_max_u32 v92, v92, v94
    v_max_u32 v93, v93, v95
    v_max_u32 v93, v93, v97
    v_mov_b32 v94, v44
    v_mov_b32 v95, v45
    v_min_u32 v97, v92, v94
    v_max_u32 v92, v92, v94
    v_max_u32 v93, v93, v95
    v_max_u32 v93, v93, v97
    v_mov_b32 v94, v46
    v_mov_b32 v95, v47
    v_min_u32 v97, v92, v94
    v_max_u32 v92, v92, v94
    v_max_u32 v93, v93, v95
    v_max_u32 v93, v93, v97
    v_mov_b32 v94, v48
    v_mov_b32 v95, v49
    v_min_u32 v97, v92, v94
    v_max_u32 v92, v92, v94
    v_max_u32 v93, v93, v95
    v_max_u32 v93, v93, v97
    v_mov_b32 v94, v50
    v_mov_b32 v95, v51
    v_min_u32 v97, v92, v94
    v_max_u32 v92, v92, v94
    v_max_u32 v93, v93, v95
    v_max_u32 v93, v93, v97
    v_mov_b32 v94, v52
    v_mov_b32 v95, v53
    v_min_u32 v97, v92, v94
    v_max_u32 v92, v92, v94
    v_max_u32 v93, v93, v95
    v_max_u32 v93, v93, v97
    v_mov_b32 v94, v54
    v_mov_b32 v95, v55
    v_min_u32 v97, v92, v94
    v_max_u32 v92, v92, v94
    v_max_u32 v93, v93, v95
    v_max_u32 v93, v93, v97
    v_and_b32 v92, 2047, v92
    v_sub_u32 v92, 2047, v92
    v_and_b32 v93, 2047, v93
    v_sub_u32 v93, 2047, v93
    s_nop 1
    v_readfirstlane_b32 s90, v92
    s_nop 1
    v_readfirstlane_b32 s91, v93
    s_mov_b32 s92, 0x00030003
    s_mov_b32 s93, 0x00030003
    s_cmp_ge_u32 s2, 172
    s_cbranch_scc1 K2_L2
    v_and_b32 v12, 15, v4
    v_cmp_eq_u32 vcc, 0, v12
    s_nop 1
    v_cndmask_b32 v13, v93, v92, vcc
    v_lshlrev_b32 v13, 10, v13
    v_lshrrev_b32 v14, 4, v4
    v_lshl_add_u32 v13, v14, 4, v13
    s_lshl_b32 s88, s84, 7
    v_mov_b32 v192, 0
    v_mov_b32 v193, 0
    v_mov_b32 v194, 0
    v_mov_b32 v195, 0
    v_mov_b32 v196, 0
    v_mov_b32 v197, 0
    v_mov_b32 v198, 0
    v_mov_b32 v199, 0
    s_mov_b64 exec, s[92:93]
    buffer_load_dwordx4 v[192:195], v13, s[28:31], s88 offen
    buffer_load_dwordx4 v[196:199], v13, s[28:31], s88 offen offset:64
    s_mov_b64 exec, -1
    v_mul_u32_u24 v12, 2752, v0
    s_lshl_b32 s88, s2, 4
    buffer_load_dwordx4 v[184:187], v12, s[16:19], s88 offen
    buffer_load_dwordx4 v[188:191], v12, s[20:23], s88 offen
K2_L2:
    s_mov_b32 s88, 0
K2_P1:
    ds_read_b128 v[84:87], v1 offset:3072
    s_waitcnt lgkmcnt(3)
    v_mfma_f32_32x32x16_bf16 v[40:55], v[72:75], v[8:11], 0
    s_nop 0
    v_max3_f32 v102, v102, v56, v57
    v_max3_f32 v100, v100, v58, v59
    v_max3_f32 v103, v103, v60, v61
    v_max3_f32 v101, v101, v62, v63
    v_max3_f32 v102, v102, v64, v65
    v_max3_f32 v100, v100, v66, v67
    v_max3_f32 v103, v103, v68, v69
    v_max3_f32 v101, v101, v70, v71
    ds_read_b128 v[72:75], v1 offset:4096
    s_waitcnt lgkmcnt(3)
    v_mfma_f32_32x32x16_bf16 v[56:71], v[76:79], v[8:11], 0
    s_nop 0
    v_max3_f32 v102, v102, v40, v41
    v_max3_f32 v100, v100, v42, v43
    v_max3_f32 v103, v103, v44, v45
    v_max3_f32 v101, v101, v46, v47
    v_max3_f32 v102, v102, v48, v49
    v_max3_f32 v100, v100, v50, v51
    v_max3_f32 v103, v103, v52, v53
    v_max3_f32 v101, v101, v54, v55
    ds_read_b128 v[76:79], v1 offset:5120
    s_waitcnt lgkmcnt(3)
    v_mfma_f32_32x32x16_bf16 v[40:55], v[80:83], v[8:11], 0
    s_nop 0
    v_max3_f32 v102, v102, v56, v57
    v_max3_f32 v100, v100, v58, v59
    v_max3_f32 v103, v103, v60, v61
    v_max3_f32 v101, v101, v62, v63
    v_max3_f32 v102, v102, v64, v65
    v_max3_f32 v100, v100, v66, v67
    v_max3_f32 v103, v103, v68, v69
    v_max3_f32 v101, v101, v70, v71
    ds_read_b128 v[80:83], v1 offset:6144
    s_waitcnt lgkmcnt(3)
    v_mfma_f32_32x32x16_bf16 v[56:71], v[84:87], v[8:11], 0
    s_nop 0
    v_max3_f32 v102, v102, v40, v41
    v_max3_f32 v100, v100, v42, v43
    v_max3_f32 v103, v103, v44, v45
    v_max3_f32 v101, v101, v46, v47
    v_max3_f32 v102, v102, v48, v49
    v_max3_f32 v100, v100, v50, v51
    v_max3_f32 v103, v103, v52, v53
    v_max3_f32 v101, v101, v54, v55
    v_add_u32 v1, 4096, v1
    s_add_u32 s88, s88, 4
    s_cmp_lt_u32 s88, 64
    s_cbranch_scc1 K2_P1
    s_nop 3
    v_max3_f32 v102, v102, v56, v57
    v_max3_f32 v100, v100, v58, v59
    v_max3_f32 v103, v103, v60, v61
    v_max3_f32 v101, v101, v62, v63
    v_max3_f32 v102, v102, v64, v65
    v_max3_f32 v100, v100, v66, v67
    v_max3_f32 v103, v103, v68, v69
    v_max3_f32 v101, v101, v70, v71
    v_max3_f32 v100, v100, v101, v102
    v_max_f32 v100, v100, v103
    v_lshlrev_b32 v1, 4, v4
    v_add_u32 v1, 24576, v1
    s_waitcnt lgkmcnt(0)
    ds_bpermute_b32 v101, v15, v100
    v_lshlrev_b32 v3, 4, v0
    v_add_u32 v3, 90112, v3
    s_waitcnt vmcnt(0) lgkmcnt(0)
    v_max_f32 v14, v100, v101
    ds_write_b128 v3, v[152:155] offset:0
    ds_write_b128 v3, v[156:159] offset:8192
    ds_write_b128 v3, v[160:163] offset:16384
    ds_write_b128 v3, v[164:167] offset:24576
    ds_write_b128 v3, v[168:171] offset:32768
    ds_write_b128 v3, v[172:175] offset:40960
    ds_write_b128 v3, v[176:179] offset:49152
    ds_write_b128 v3, v[180:183] offset:57344
    s_mov_b32 s94, 0
    s_cmp_ge_u32 s2, 172
    s_cbranch_scc1 K2_NOG
    v_lshrrev_b32 v3, 4, v4
    v_lshlrev_b32 v3, 3, v3
    v_bfe_u32 v13, v4, 2, 2
    v_add_u32 v3, v3, v13
    v_lshlrev_b32 v3, 5, v3
    v_and_b32 v13, 3, v4
    v_lshl_add_u32 v3, v13, 3, v3
    v_lshlrev_b32 v12, 5, v0
    ds_write_b128 v12, v[184:187] offset:0
    ds_write_b128 v12, v[188:191] offset:16
    v_lshl_add_u32 v12, v5, 11, v3
    s_waitcnt lgkmcnt(0)
    s_barrier
    ds_read_b64_tr_b16 v[200:201], v12 offset:0
    ds_read_b64_tr_b16 v[202:203], v12 offset:128
    ds_read_b64_tr_b16 v[204:205], v12 offset:1024
    ds_read_b64_tr_b16 v[206:207], v12 offset:1152
    v_and_b32 v12, 15, v4
    v_lshrrev_b32 v13, 4, v4
    v_lshlrev_b32 v213, 7, v5
    v_lshl_add_u32 v213, v12, 6, v213
    v_lshl_add_u32 v213, v13, 4, v213
    s_waitcnt lgkmcnt(0)
    v_mfma_f32_16x16x32_bf16 v[208:211], v[200:203], v[192:195], 0
    v_mfma_f32_16x16x32_bf16 v[208:211], v[204:207], v[196:199], v[208:211]
    s_nop 7
    s_nop 1
    s_mov_b64 exec, s[92:93]
    ds_write_b128 v213, v[208:211] offset:16512
    s_mov_b64 exec, -1
    s_waitcnt lgkmcnt(0)
    s_barrier
    s_cmp_lg_u32 s84, 0
    s_cbranch_scc1 K2_NOD
    v_bfe_u32 v214, v4, 3, 1
    v_and_b32 v213, 7, v4
    v_lshlrev_b32 v212, 6, v214
    v_lshl_add_u32 v212, v213, 2, v212
    ds_read_b32 v216, v212 offset:16512
    ds_read_b32 v217, v212 offset:16544
    ds_read_b32 v218, v212 offset:16640
    ds_read_b32 v219, v212 offset:16672
    ds_read_b32 v220, v212 offset:16768
    ds_read_b32 v221, v212 offset:16800
    ds_read_b32 v222, v212 offset:16896
    ds_read_b32 v223, v212 offset:16928
    ds_read_b32 v224, v212 offset:17024
    ds_read_b32 v225, v212 offset:17056
    ds_read_b32 v226, v212 offset:17152
    ds_read_b32 v227, v212 offset:17184
    ds_read_b32 v228, v212 offset:17280
    ds_read_b32 v229, v212 offset:17312
    ds_read_b32 v230, v212 offset:17408
    ds_read_b32 v231, v212 offset:17440
    s_lshl_b32 s88, s2, 4
    s_add_u32 s88, s88, 4096
    s_waitcnt lgkmcnt(0)
    v_lshlrev_b32 v212, 12, v214
    v_lshl_add_u32 v212, v213, 1, v212
    v_add_f32 v216, v216, v218
    v_add_f32 v217, v217, v219
    v_add_f32 v216, v216, v220
    v_add_f32 v217, v217, v221
    v_add_f32 v216, v216, v222
    v_add_f32 v217, v217, v223
    v_add_f32 v216, v216, v224
    v_add_f32 v217, v217, v225
    v_add_f32 v216, v216, v226
    v_add_f32 v217, v217, v227
    v_add_f32 v216, v216, v228
    v_add_f32 v217, v217, v229
    v_add_f32 v216, v216, v230
    v_add_f32 v217, v217, v231
    v_cvt_pk_bf16_f32 v216, 0, v216
    v_cvt_pk_bf16_f32 v217, 0, v217
    v_mul_f32 v218, 0xbfb8aa3b, v216
    v_exp_f32 v218, v218
    s_nop 1
    v_add_f32 v218, 1.0, v218
    v_rcp_f32 v218, v218
    s_nop 1
    v_mul_f32 v218, v216, v218
    v_cvt_pk_bf16_f32 v218, 0, v218
    v_mul_f32 v218, v218, v217
    v_cvt_pk_bf16_f32 v218, v218, v218
    s_mov_b64 exec, 0xffff
    buffer_store_short v218, v212, s[76:79], s88 offen sc1
    s_mov_b64 exec, -1
    s_mov_b32 s94, 1
    s_branch K2_NOD
K2_NOG:
    s_waitcnt lgkmcnt(0)
    s_barrier
    s_cmp_lt_u32 s2, 224
    s_cbranch_scc1 K2_NOD
    v_lshlrev_b32 v12, 4, v4
    s_lshl_b32 s88, s84, 5
    s_add_u32 s88, s88, s2
    s_sub_u32 s88, s88, 224
    s_lshl_b32 s88, s88, 10
    buffer_load_dwordx4 v[232:235], v12, s[24:27], s88 offen
    s_add_u32 s88, s88, 0x40000
    buffer_load_dwordx4 v[236:239], v12, s[24:27], s88 offen
    s_add_u32 s88, s88, 0x40000
    buffer_load_dwordx4 v[240:243], v12, s[24:27], s88 offen
    s_add_u32 s88, s88, 0x40000
    buffer_load_dwordx4 v[244:247], v12, s[24:27], s88 offen
    s_add_u32 s88, s88, 0x40000
    buffer_load_dwordx4 v[248:251], v12, s[24:27], s88 offen
    s_add_u32 s88, s88, 0x40000
    buffer_load_dwordx4 v[252:255], v12, s[24:27], s88 offen
    s_mov_b32 s94, 2
K2_NOD:
    ds_read_b128 v[16:19], v1
    ds_read_b128 v[20:23], v1 offset:1024
    v_sub_f32 v88, 0, v14
    v_sub_f32 v89, 0, v14
    v_sub_f32 v90, 0, v14
    v_sub_f32 v91, 0, v14
    v_sub_f32 v92, 0, v14
    v_sub_f32 v93, 0, v14
    v_sub_f32 v94, 0, v14
    v_sub_f32 v95, 0, v14
    v_sub_f32 v96, 0, v14
    v_sub_f32 v97, 0, v14
    v_sub_f32 v98, 0, v14
    v_sub_f32 v99, 0, v14
    v_sub_f32 v100, 0, v14
    v_sub_f32 v101, 0, v14
    v_sub_f32 v102, 0, v14
    v_sub_f32 v103, 0, v14
    v_mov_b32 v104, 0
    v_mov_b32 v105, 0
    v_mov_b32 v106, 0
    v_mov_b32 v107, 0
    v_mov_b32 v108, 0
    v_mov_b32 v109, 0
    v_mov_b32 v110, 0
    v_mov_b32 v111, 0
    v_mov_b32 v112, 0
    v_mov_b32 v113, 0
    v_mov_b32 v114, 0
    v_mov_b32 v115, 0
    v_mov_b32 v116, 0
    v_mov_b32 v117, 0
    v_mov_b32 v118, 0
    v_mov_b32 v119, 0
    v_mov_b32 v80, 0
    v_mov_b32 v81, 0
    v_mov_b32 v82, 0
    v_mov_b32 v83, 0
    v_mov_b32 v84, 0
    v_mov_b32 v85, 0
    v_mov_b32 v86, 0
    v_mov_b32 v87, 0
    s_waitcnt lgkmcnt(0)
    v_mfma_f32_32x32x16_bf16 v[40:55], v[16:19], v[8:11], v[88:103]
    s_lshl_b32 s13, s84, 16
    v_lshlrev_b32 v3, 4, v4
    s_nop 7
    s_nop 3
    v_mfma_f32_32x32x16_bf16 v[56:71], v[20:23], v[8:11], v[88:103]
    ds_read_b128 v[16:19], v1 offset:2048
    s_mov_b64 exec, s[86:87]
    ds_read_b128 v[24:27], v2 offset:0
    ds_read_b128 v[28:31], v2 offset:512
    s_mov_b64 exec, -1
    v_exp_f32 v40, v40
    v_exp_f32 v41, v41
    v_exp_f32 v42, v42
    v_exp_f32 v43, v43
    v_exp_f32 v44, v44
    v_mfma_f32_32x32x16_bf16 v[104:119], v[32:35], v[80:83], v[104:119]
    v_exp_f32 v45, v45
    v_exp_f32 v46, v46
    v_exp_f32 v47, v47
    v_exp_f32 v48, v48
    v_exp_f32 v49, v49
    v_mfma_f32_32x32x16_bf16 v[104:119], v[36:39], v[84:87], v[104:119]
    buffer_load_dwordx4 v[120:123], v3, s[32:35], s13 offen offset:0
    v_exp_f32 v50, v50
    v_exp_f32 v51, v51
    v_exp_f32 v52, v52
    v_exp_f32 v53, v53
    v_exp_f32 v54, v54
    v_exp_f32 v55, v55
    v_cvt_pk_bf16_f32 v72, v40, v41
    v_cvt_pk_bf16_f32 v73, v42, v43
    v_cvt_pk_bf16_f32 v74, v44, v45
    v_cvt_pk_bf16_f32 v75, v46, v47
    v_cvt_pk_bf16_f32 v76, v48, v49
    v_cvt_pk_bf16_f32 v77, v50, v51
    v_cvt_pk_bf16_f32 v78, v52, v53
    v_cvt_pk_bf16_f32 v79, v54, v55
    s_waitcnt lgkmcnt(0)
    v_mfma_f32_32x32x16_bf16 v[40:55], v[16:19], v[8:11], v[88:103]
    ds_read_b128 v[20:23], v1 offset:3072
    s_mov_b64 exec, s[86:87]
    ds_read_b128 v[32:35], v2 offset:1024
    ds_read_b128 v[36:39], v2 offset:1536
    s_mov_b64 exec, -1
    v_exp_f32 v56, v56
    v_exp_f32 v57, v57
    v_exp_f32 v58, v58
    v_exp_f32 v59, v59
    v_exp_f32 v60, v60
    v_mfma_f32_32x32x16_bf16 v[104:119], v[24:27], v[72:75], v[104:119]
    v_exp_f32 v61, v61
    v_exp_f32 v62, v62
    v_exp_f32 v63, v63
    v_exp_f32 v64, v64
    v_exp_f32 v65, v65
    v_mfma_f32_32x32x16_bf16 v[104:119], v[28:31], v[76:79], v[104:119]
    buffer_load_dwordx4 v[124:127], v3, s[32:35], s13 offen offset:1024
    v_exp_f32 v66, v66
    v_exp_f32 v67, v67
    v_exp_f32 v68, v68
    v_exp_f32 v69, v69
    v_exp_f32 v70, v70
    v_exp_f32 v71, v71
    v_cvt_pk_bf16_f32 v80, v56, v57
    v_cvt_pk_bf16_f32 v81, v58, v59
    v_cvt_pk_bf16_f32 v82, v60, v61
    v_cvt_pk_bf16_f32 v83, v62, v63
    v_cvt_pk_bf16_f32 v84, v64, v65
    v_cvt_pk_bf16_f32 v85, v66, v67
    v_cvt_pk_bf16_f32 v86, v68, v69
    v_cvt_pk_bf16_f32 v87, v70, v71
    s_waitcnt lgkmcnt(0)
    v_mfma_f32_32x32x16_bf16 v[56:71], v[20:23], v[8:11], v[88:103]
    ds_read_b128 v[16:19], v1 offset:4096
    s_mov_b64 exec, s[86:87]
    ds_read_b128 v[24:27], v2 offset:2048
    ds_read_b128 v[28:31], v2 offset:2560
    s_mov_b64 exec, -1
    v_exp_f32 v40, v40
    v_exp_f32 v41, v41
    v_exp_f32 v42, v42
    v_exp_f32 v43, v43
    v_exp_f32 v44, v44
    v_mfma_f32_32x32x16_bf16 v[104:119], v[32:35], v[80:83], v[104:119]
    v_exp_f32 v45, v45
    v_exp_f32 v46, v46
    v_exp_f32 v47, v47
    v_exp_f32 v48, v48
    v_exp_f32 v49, v49
    v_mfma_f32_32x32x16_bf16 v[104:119], v[36:39], v[84:87], v[104:119]
    buffer_load_dwordx4 v[128:131], v3, s[32:35], s13 offen offset:2048
    v_exp_f32 v50, v50
    v_exp_f32 v51, v51
    v_exp_f32 v52, v52
    v_exp_f32 v53, v53
    v_exp_f32 v54, v54
    v_exp_f32 v55, v55
    v_cvt_pk_bf16_f32 v72, v40, v41
    v_cvt_pk_bf16_f32 v73, v42, v43
    v_cvt_pk_bf16_f32 v74, v44, v45
    v_cvt_pk_bf16_f32 v75, v46, v47
    v_cvt_pk_bf16_f32 v76, v48, v49
    v_cvt_pk_bf16_f32 v77, v50, v51
    v_cvt_pk_bf16_f32 v78, v52, v53
    v_cvt_pk_bf16_f32 v79, v54, v55
    s_waitcnt lgkmcnt(0)
    v_mfma_f32_32x32x16_bf16 v[40:55], v[16:19], v[8:11], v[88:103]
    ds_read_b128 v[20:23], v1 offset:5120
    s_mov_b64 exec, s[86:87]
    ds_read_b128 v[32:35], v2 offset:3072
    ds_read_b128 v[36:39], v2 offset:3584
    s_mov_b64 exec, -1
    v_exp_f32 v56, v56
    v_exp_f32 v57, v57
    v_exp_f32 v58, v58
    v_exp_f32 v59, v59
    v_exp_f32 v60, v60
    v_mfma_f32_32x32x16_bf16 v[104:119], v[24:27], v[72:75], v[104:119]
    v_exp_f32 v61, v61
    v_exp_f32 v62, v62
    v_exp_f32 v63, v63
    v_exp_f32 v64, v64
    v_exp_f32 v65, v65
    v_mfma_f32_32x32x16_bf16 v[104:119], v[28:31], v[76:79], v[104:119]
    buffer_load_dwordx4 v[132:135], v3, s[32:35], s13 offen offset:3072
    v_exp_f32 v66, v66
    v_exp_f32 v67, v67
    v_exp_f32 v68, v68
    v_exp_f32 v69, v69
    v_exp_f32 v70, v70
    v_exp_f32 v71, v71
    v_cvt_pk_bf16_f32 v80, v56, v57
    v_cvt_pk_bf16_f32 v81, v58, v59
    v_cvt_pk_bf16_f32 v82, v60, v61
    v_cvt_pk_bf16_f32 v83, v62, v63
    v_cvt_pk_bf16_f32 v84, v64, v65
    v_cvt_pk_bf16_f32 v85, v66, v67
    v_cvt_pk_bf16_f32 v86, v68, v69
    v_cvt_pk_bf16_f32 v87, v70, v71
    s_waitcnt lgkmcnt(0)
    v_mfma_f32_32x32x16_bf16 v[56:71], v[20:23], v[8:11], v[88:103]
    ds_read_b128 v[16:19], v1 offset:6144
    s_mov_b64 exec, s[86:87]
    ds_read_b128 v[24:27], v2 offset:4096
    ds_read_b128 v[28:31], v2 offset:4608
    s_mov_b64 exec, -1
    v_exp_f32 v40, v40
    v_exp_f32 v41, v41
    v_exp_f32 v42, v42
    v_exp_f32 v43, v43
    v_exp_f32 v44, v44
    v_mfma_f32_32x32x16_bf16 v[104:119], v[32:35], v[80:83], v[104:119]
    v_exp_f32 v45, v45
    v_exp_f32 v46, v46
    v_exp_f32 v47, v47
    v_exp_f32 v48, v48
    v_exp_f32 v49, v49
    v_mfma_f32_32x32x16_bf16 v[104:119], v[36:39], v[84:87], v[104:119]
    v_exp_f32 v50, v50
    v_exp_f32 v51, v51
    v_exp_f32 v52, v52
    v_exp_f32 v53, v53
    v_exp_f32 v54, v54
    v_exp_f32 v55, v55
    v_cvt_pk_bf16_f32 v72, v40, v41
    v_cvt_pk_bf16_f32 v73, v42, v43
    v_cvt_pk_bf16_f32 v74, v44, v45
    v_cvt_pk_bf16_f32 v75, v46, v47
    v_cvt_pk_bf16_f32 v76, v48, v49
    v_cvt_pk_bf16_f32 v77, v50, v51
    v_cvt_pk_bf16_f32 v78, v52, v53
    v_cvt_pk_bf16_f32 v79, v54, v55
    s_waitcnt lgkmcnt(0)
    v_mfma_f32_32x32x16_bf16 v[40:55], v[16:19], v[8:11], v[88:103]
    ds_read_b128 v[20:23], v1 offset:7168
    s_mov_b64 exec, s[86:87]
    ds_read_b128 v[32:35], v2 offset:5120
    ds_read_b128 v[36:39], v2 offset:5632
    s_mov_b64 exec, -1
    v_exp_f32 v56, v56
    v_exp_f32 v57, v57
    v_exp_f32 v58, v58
    v_exp_f32 v59, v59
    v_exp_f32 v60, v60
    v_mfma_f32_32x32x16_bf16 v[104:119], v[24:27], v[72:75], v[104:119]
    v_exp_f32 v61, v61
    v_exp_f32 v62, v62
    v_exp_f32 v63, v63
    v_exp_f32 v64, v64
    v_exp_f32 v65, v65
    v_mfma_f32_32x32x16_bf16 v[104:119], v[28:31], v[76:79], v[104:119]
    s_add_u32 s13, s13, 4096
    buffer_load_dwordx4 v[136:139], v3, s[32:35], s13 offen offset:0
    v_exp_f32 v66, v66
    v_exp_f32 v67, v67
    v_exp_f32 v68, v68
    v_exp_f32 v69, v69
    v_exp_f32 v70, v70
    v_exp_f32 v71, v71
    v_cvt_pk_bf16_f32 v80, v56, v57
    v_cvt_pk_bf16_f32 v81, v58, v59
    v_cvt_pk_bf16_f32 v82, v60, v61
    v_cvt_pk_bf16_f32 v83, v62, v63
    v_cvt_pk_bf16_f32 v84, v64, v65
    v_cvt_pk_bf16_f32 v85, v66, v67
    v_cvt_pk_bf16_f32 v86, v68, v69
    v_cvt_pk_bf16_f32 v87, v70, v71
    s_waitcnt lgkmcnt(0)
    v_mfma_f32_32x32x16_bf16 v[56:71], v[20:23], v[8:11], v[88:103]
    ds_read_b128 v[16:19], v1 offset:8192
    s_mov_b64 exec, s[86:87]
    ds_read_b128 v[24:27], v2 offset:6144
    ds_read_b128 v[28:31], v2 offset:6656
    s_mov_b64 exec, -1
    v_exp_f32 v40, v40
    v_exp_f32 v41, v41
    v_exp_f32 v42, v42
    v_exp_f32 v43, v43
    v_exp_f32 v44, v44
    v_mfma_f32_32x32x16_bf16 v[104:119], v[32:35], v[80:83], v[104:119]
    v_exp_f32 v45, v45
    v_exp_f32 v46, v46
    v_exp_f32 v47, v47
    v_exp_f32 v48, v48
    v_exp_f32 v49, v49
    v_mfma_f32_32x32x16_bf16 v[104:119], v[36:39], v[84:87], v[104:119]
    v_exp_f32 v50, v50
    v_exp_f32 v51, v51
    v_exp_f32 v52, v52
    v_exp_f32 v53, v53
    v_exp_f32 v54, v54
    v_exp_f32 v55, v55
    v_cvt_pk_bf16_f32 v72, v40, v41
    v_cvt_pk_bf16_f32 v73, v42, v43
    v_cvt_pk_bf16_f32 v74, v44, v45
    v_cvt_pk_bf16_f32 v75, v46, v47
    v_cvt_pk_bf16_f32 v76, v48, v49
    v_cvt_pk_bf16_f32 v77, v50, v51
    v_cvt_pk_bf16_f32 v78, v52, v53
    v_cvt_pk_bf16_f32 v79, v54, v55
    s_waitcnt lgkmcnt(0)
    v_mfma_f32_32x32x16_bf16 v[40:55], v[16:19], v[8:11], v[88:103]
    ds_read_b128 v[20:23], v1 offset:9216
    s_mov_b64 exec, s[86:87]
    ds_read_b128 v[32:35], v2 offset:7168
    ds_read_b128 v[36:39], v2 offset:7680
    s_mov_b64 exec, -1
    v_exp_f32 v56, v56
    v_exp_f32 v57, v57
    v_exp_f32 v58, v58
    v_exp_f32 v59, v59
    v_exp_f32 v60, v60
    v_mfma_f32_32x32x16_bf16 v[104:119], v[24:27], v[72:75], v[104:119]
    v_exp_f32 v61, v61
    v_exp_f32 v62, v62
    v_exp_f32 v63, v63
    v_exp_f32 v64, v64
    v_exp_f32 v65, v65
    v_mfma_f32_32x32x16_bf16 v[104:119], v[28:31], v[76:79], v[104:119]
    buffer_load_dwordx4 v[140:143], v3, s[32:35], s13 offen offset:1024
    v_exp_f32 v66, v66
    v_exp_f32 v67, v67
    v_exp_f32 v68, v68
    v_exp_f32 v69, v69
    v_exp_f32 v70, v70
    v_exp_f32 v71, v71
    v_cvt_pk_bf16_f32 v80, v56, v57
    v_cvt_pk_bf16_f32 v81, v58, v59
    v_cvt_pk_bf16_f32 v82, v60, v61
    v_cvt_pk_bf16_f32 v83, v62, v63
    v_cvt_pk_bf16_f32 v84, v64, v65
    v_cvt_pk_bf16_f32 v85, v66, v67
    v_cvt_pk_bf16_f32 v86, v68, v69
    v_cvt_pk_bf16_f32 v87, v70, v71
    s_waitcnt lgkmcnt(0)
    v_mfma_f32_32x32x16_bf16 v[56:71], v[20:23], v[8:11], v[88:103]
    ds_read_b128 v[16:19], v1 offset:10240
    s_mov_b64 exec, s[86:87]
    ds_read_b128 v[24:27], v2 offset:8192
    ds_read_b128 v[28:31], v2 offset:8704
    s_mov_b64 exec, -1
    v_exp_f32 v40, v40
    v_exp_f32 v41, v41
    v_exp_f32 v42, v42
    v_exp_f32 v43, v43
    v_exp_f32 v44, v44
    v_mfma_f32_32x32x16_bf16 v[104:119], v[32:35], v[80:83], v[104:119]
    v_exp_f32 v45, v45
    v_exp_f32 v46, v46
    v_exp_f32 v47, v47
    v_exp_f32 v48, v48
    v_exp_f32 v49, v49
    v_mfma_f32_32x32x16_bf16 v[104:119], v[36:39], v[84:87], v[104:119]
    v_exp_f32 v50, v50
    v_exp_f32 v51, v51
    v_exp_f32 v52, v52
    v_exp_f32 v53, v53
    v_exp_f32 v54, v54
    v_exp_f32 v55, v55
    v_cvt_pk_bf16_f32 v72, v40, v41
    v_cvt_pk_bf16_f32 v73, v42, v43
    v_cvt_pk_bf16_f32 v74, v44, v45
    v_cvt_pk_bf16_f32 v75, v46, v47
    v_cvt_pk_bf16_f32 v76, v48, v49
    v_cvt_pk_bf16_f32 v77, v50, v51
    v_cvt_pk_bf16_f32 v78, v52, v53
    v_cvt_pk_bf16_f32 v79, v54, v55
    s_waitcnt lgkmcnt(0)
    s_cmp_eq_u32 s94, 1
    s_cbranch_scc1 K2_SIG1
K2_SIG1R:
    v_mfma_f32_32x32x16_bf16 v[40:55], v[16:19], v[8:11], v[88:103]
    ds_read_b128 v[20:23], v1 offset:11264
    s_mov_b64 exec, s[86:87]
    ds_read_b128 v[32:35], v2 offset:9216
    ds_read_b128 v[36:39], v2 offset:9728
    s_mov_b64 exec, -1
    v_exp_f32 v56, v56
    v_exp_f32 v57, v57
    v_exp_f32 v58, v58
    v_exp_f32 v59, v59
    v_exp_f32 v60, v60
    v_mfma_f32_32x32x16_bf16 v[104:119], v[24:27], v[72:75], v[104:119]
    v_exp_f32 v61, v61
    v_exp_f32 v62, v62
    v_exp_f32 v63, v63
    v_exp_f32 v64, v64
    v_exp_f32 v65, v65
    v_mfma_f32_32x32x16_bf16 v[104:119], v[28:31], v[76:79], v[104:119]
    buffer_load_dwordx4 v[144:147], v3, s[32:35], s13 offen offset:2048
    v_exp_f32 v66, v66
    v_exp_f32 v67, v67
    v_exp_f32 v68, v68
    v_exp_f32 v69, v69
    v_exp_f32 v70, v70
    v_exp_f32 v71, v71
    v_cvt_pk_bf16_f32 v80, v56, v57
    v_cvt_pk_bf16_f32 v81, v58, v59
    v_cvt_pk_bf16_f32 v82, v60, v61
    v_cvt_pk_bf16_f32 v83, v62, v63
    v_cvt_pk_bf16_f32 v84, v64, v65
    v_cvt_pk_bf16_f32 v85, v66, v67
    v_cvt_pk_bf16_f32 v86, v68, v69
    v_cvt_pk_bf16_f32 v87, v70, v71
    s_waitcnt lgkmcnt(0)
    v_mfma_f32_32x32x16_bf16 v[56:71], v[20:23], v[8:11], v[88:103]
    ds_read_b128 v[16:19], v1 offset:12288
    s_mov_b64 exec, s[86:87]
    ds_read_b128 v[24:27], v2 offset:10240
    ds_read_b128 v[28:31], v2 offset:10752
    s_mov_b64 exec, -1
    v_exp_f32 v40, v40
    v_exp_f32 v41, v41
    v_exp_f32 v42, v42
    v_exp_f32 v43, v43
    v_exp_f32 v44, v44
    v_mfma_f32_32x32x16_bf16 v[104:119], v[32:35], v[80:83], v[104:119]
    v_exp_f32 v45, v45
    v_exp_f32 v46, v46
    v_exp_f32 v47, v47
    v_exp_f32 v48, v48
    v_exp_f32 v49, v49
    v_mfma_f32_32x32x16_bf16 v[104:119], v[36:39], v[84:87], v[104:119]
    v_exp_f32 v50, v50
    v_exp_f32 v51, v51
    v_exp_f32 v52, v52
    v_exp_f32 v53, v53
    v_exp_f32 v54, v54
    v_exp_f32 v55, v55
    v_cvt_pk_bf16_f32 v72, v40, v41
    v_cvt_pk_bf16_f32 v73, v42, v43
    v_cvt_pk_bf16_f32 v74, v44, v45
    v_cvt_pk_bf16_f32 v75, v46, v47
    v_cvt_pk_bf16_f32 v76, v48, v49
    v_cvt_pk_bf16_f32 v77, v50, v51
    v_cvt_pk_bf16_f32 v78, v52, v53
    v_cvt_pk_bf16_f32 v79, v54, v55
    s_waitcnt lgkmcnt(0)
    v_mfma_f32_32x32x16_bf16 v[40:55], v[16:19], v[8:11], v[88:103]
    ds_read_b128 v[20:23], v1 offset:13312
    s_mov_b64 exec, s[86:87]
    ds_read_b128 v[32:35], v2 offset:11264
    ds_read_b128 v[36:39], v2 offset:11776
    s_mov_b64 exec, -1
    v_exp_f32 v56, v56
    v_exp_f32 v57, v57
    v_exp_f32 v58, v58
    v_exp_f32 v59, v59
    v_exp_f32 v60, v60
    v_mfma_f32_32x32x16_bf16 v[104:119], v[24:27], v[72:75], v[104:119]
    v_exp_f32 v61, v61
    v_exp_f32 v62, v62
    v_exp_f32 v63, v63
    v_exp_f32 v64, v64
    v_exp_f32 v65, v65
    v_mfma_f32_32x32x16_bf16 v[104:119], v[28:31], v[76:79], v[104:119]
    buffer_load_dwordx4 v[148:151], v3, s[32:35], s13 offen offset:3072
    v_exp_f32 v66, v66
    v_exp_f32 v67, v67
    v_exp_f32 v68, v68
    v_exp_f32 v69, v69
    v_exp_f32 v70, v70
    v_exp_f32 v71, v71
    v_cvt_pk_bf16_f32 v80, v56, v57
    v_cvt_pk_bf16_f32 v81, v58, v59
    v_cvt_pk_bf16_f32 v82, v60, v61
    v_cvt_pk_bf16_f32 v83, v62, v63
    v_cvt_pk_bf16_f32 v84, v64, v65
    v_cvt_pk_bf16_f32 v85, v66, v67
    v_cvt_pk_bf16_f32 v86, v68, v69
    v_cvt_pk_bf16_f32 v87, v70, v71
    s_waitcnt lgkmcnt(0)
    v_mfma_f32_32x32x16_bf16 v[56:71], v[20:23], v[8:11], v[88:103]
    ds_read_b128 v[16:19], v1 offset:14336
    s_mov_b64 exec, s[86:87]
    ds_read_b128 v[24:27], v2 offset:12288
    ds_read_b128 v[28:31], v2 offset:12800
    s_mov_b64 exec, -1
    v_exp_f32 v40, v40
    v_exp_f32 v41, v41
    v_exp_f32 v42, v42
    v_exp_f32 v43, v43
    v_exp_f32 v44, v44
    v_mfma_f32_32x32x16_bf16 v[104:119], v[32:35], v[80:83], v[104:119]
    v_exp_f32 v45, v45
    v_exp_f32 v46, v46
    v_exp_f32 v47, v47
    v_exp_f32 v48, v48
    v_exp_f32 v49, v49
    v_mfma_f32_32x32x16_bf16 v[104:119], v[36:39], v[84:87], v[104:119]
    v_exp_f32 v50, v50
    v_exp_f32 v51, v51
    v_exp_f32 v52, v52
    v_exp_f32 v53, v53
    v_exp_f32 v54, v54
    v_exp_f32 v55, v55
    v_cvt_pk_bf16_f32 v72, v40, v41
    v_cvt_pk_bf16_f32 v73, v42, v43
    v_cvt_pk_bf16_f32 v74, v44, v45
    v_cvt_pk_bf16_f32 v75, v46, v47
    v_cvt_pk_bf16_f32 v76, v48, v49
    v_cvt_pk_bf16_f32 v77, v50, v51
    v_cvt_pk_bf16_f32 v78, v52, v53
    v_cvt_pk_bf16_f32 v79, v54, v55
    s_waitcnt lgkmcnt(0)
    v_mfma_f32_32x32x16_bf16 v[40:55], v[16:19], v[8:11], v[88:103]
    ds_read_b128 v[20:23], v1 offset:15360
    s_mov_b64 exec, s[86:87]
    ds_read_b128 v[32:35], v2 offset:13312
    ds_read_b128 v[36:39], v2 offset:13824
    s_mov_b64 exec, -1
    v_exp_f32 v56, v56
    v_exp_f32 v57, v57
    v_exp_f32 v58, v58
    v_exp_f32 v59, v59
    v_exp_f32 v60, v60
    v_mfma_f32_32x32x16_bf16 v[104:119], v[24:27], v[72:75], v[104:119]
    v_exp_f32 v61, v61
    v_exp_f32 v62, v62
    v_exp_f32 v63, v63
    v_exp_f32 v64, v64
    v_exp_f32 v65, v65
    v_mfma_f32_32x32x16_bf16 v[104:119], v[28:31], v[76:79], v[104:119]
    s_add_u32 s13, s13, 4096
    buffer_load_dwordx4 v[152:155], v3, s[32:35], s13 offen offset:0
    v_exp_f32 v66, v66
    v_exp_f32 v67, v67
    v_exp_f32 v68, v68
    v_exp_f32 v69, v69
    v_exp_f32 v70, v70
    v_exp_f32 v71, v71
    v_cvt_pk_bf16_f32 v80, v56, v57
    v_cvt_pk_bf16_f32 v81, v58, v59
    v_cvt_pk_bf16_f32 v82, v60, v61
    v_cvt_pk_bf16_f32 v83, v62, v63
    v_cvt_pk_bf16_f32 v84, v64, v65
    v_cvt_pk_bf16_f32 v85, v66, v67
    v_cvt_pk_bf16_f32 v86, v68, v69
    v_cvt_pk_bf16_f32 v87, v70, v71
    s_waitcnt lgkmcnt(0)
    v_mfma_f32_32x32x16_bf16 v[56:71], v[20:23], v[8:11], v[88:103]
    ds_read_b128 v[16:19], v1 offset:16384
    s_mov_b64 exec, s[86:87]
    ds_read_b128 v[24:27], v2 offset:14336
    ds_read_b128 v[28:31], v2 offset:14848
    s_mov_b64 exec, -1
    v_exp_f32 v40, v40
    v_exp_f32 v41, v41
    v_exp_f32 v42, v42
    v_exp_f32 v43, v43
    v_exp_f32 v44, v44
    v_mfma_f32_32x32x16_bf16 v[104:119], v[32:35], v[80:83], v[104:119]
    v_exp_f32 v45, v45
    v_exp_f32 v46, v46
    v_exp_f32 v47, v47
    v_exp_f32 v48, v48
    v_exp_f32 v49, v49
    v_mfma_f32_32x32x16_bf16 v[104:119], v[36:39], v[84:87], v[104:119]
    v_exp_f32 v50, v50
    v_exp_f32 v51, v51
    v_exp_f32 v52, v52
    v_exp_f32 v53, v53
    v_exp_f32 v54, v54
    v_exp_f32 v55, v55
    v_cvt_pk_bf16_f32 v72, v40, v41
    v_cvt_pk_bf16_f32 v73, v42, v43
    v_cvt_pk_bf16_f32 v74, v44, v45
    v_cvt_pk_bf16_f32 v75, v46, v47
    v_cvt_pk_bf16_f32 v76, v48, v49
    v_cvt_pk_bf16_f32 v77, v50, v51
    v_cvt_pk_bf16_f32 v78, v52, v53
    v_cvt_pk_bf16_f32 v79, v54, v55
    s_waitcnt lgkmcnt(0)
    v_mfma_f32_32x32x16_bf16 v[40:55], v[16:19], v[8:11], v[88:103]
    ds_read_b128 v[20:23], v1 offset:17408
    s_mov_b64 exec, s[86:87]
    ds_read_b128 v[32:35], v2 offset:15360
    ds_read_b128 v[36:39], v2 offset:15872
    s_mov_b64 exec, -1
    v_exp_f32 v56, v56
    v_exp_f32 v57, v57
    v_exp_f32 v58, v58
    v_exp_f32 v59, v59
    v_exp_f32 v60, v60
    v_mfma_f32_32x32x16_bf16 v[104:119], v[24:27], v[72:75], v[104:119]
    v_exp_f32 v61, v61
    v_exp_f32 v62, v62
    v_exp_f32 v63, v63
    v_exp_f32 v64, v64
    v_exp_f32 v65, v65
    v_mfma_f32_32x32x16_bf16 v[104:119], v[28:31], v[76:79], v[104:119]
    buffer_load_dwordx4 v[156:159], v3, s[32:35], s13 offen offset:1024
    v_exp_f32 v66, v66
    v_exp_f32 v67, v67
    v_exp_f32 v68, v68
    v_exp_f32 v69, v69
    v_exp_f32 v70, v70
    v_exp_f32 v71, v71
    v_cvt_pk_bf16_f32 v80, v56, v57
    v_cvt_pk_bf16_f32 v81, v58, v59
    v_cvt_pk_bf16_f32 v82, v60, v61
    v_cvt_pk_bf16_f32 v83, v62, v63
    v_cvt_pk_bf16_f32 v84, v64, v65
    v_cvt_pk_bf16_f32 v85, v66, v67
    v_cvt_pk_bf16_f32 v86, v68, v69
    v_cvt_pk_bf16_f32 v87, v70, v71
    s_waitcnt lgkmcnt(0)
    v_mfma_f32_32x32x16_bf16 v[56:71], v[20:23], v[8:11], v[88:103]
    ds_read_b128 v[16:19], v1 offset:18432
    s_mov_b64 exec, s[86:87]
    ds_read_b128 v[24:27], v2 offset:16384
    ds_read_b128 v[28:31], v2 offset:16896
    s_mov_b64 exec, -1
    v_exp_f32 v40, v40
    v_exp_f32 v41, v41
    v_exp_f32 v42, v42
    v_exp_f32 v43, v43
    v_exp_f32 v44, v44
    v_mfma_f32_32x32x16_bf16 v[104:119], v[32:35], v[80:83], v[104:119]
    v_exp_f32 v45, v45
    v_exp_f32 v46, v46
    v_exp_f32 v47, v47
    v_exp_f32 v48, v48
    v_exp_f32 v49, v49
    v_mfma_f32_32x32x16_bf16 v[104:119], v[36:39], v[84:87], v[104:119]
    v_exp_f32 v50, v50
    v_exp_f32 v51, v51
    v_exp_f32 v52, v52
    v_exp_f32 v53, v53
    v_exp_f32 v54, v54
    v_exp_f32 v55, v55
    v_cvt_pk_bf16_f32 v72, v40, v41
    v_cvt_pk_bf16_f32 v73, v42, v43
    v_cvt_pk_bf16_f32 v74, v44, v45
    v_cvt_pk_bf16_f32 v75, v46, v47
    v_cvt_pk_bf16_f32 v76, v48, v49
    v_cvt_pk_bf16_f32 v77, v50, v51
    v_cvt_pk_bf16_f32 v78, v52, v53
    v_cvt_pk_bf16_f32 v79, v54, v55
    s_waitcnt lgkmcnt(0)
    v_mfma_f32_32x32x16_bf16 v[40:55], v[16:19], v[8:11], v[88:103]
    ds_read_b128 v[20:23], v1 offset:19456
    s_mov_b64 exec, s[86:87]
    ds_read_b128 v[32:35], v2 offset:17408
    ds_read_b128 v[36:39], v2 offset:17920
    s_mov_b64 exec, -1
    v_exp_f32 v56, v56
    v_exp_f32 v57, v57
    v_exp_f32 v58, v58
    v_exp_f32 v59, v59
    v_exp_f32 v60, v60
    v_mfma_f32_32x32x16_bf16 v[104:119], v[24:27], v[72:75], v[104:119]
    v_exp_f32 v61, v61
    v_exp_f32 v62, v62
    v_exp_f32 v63, v63
    v_exp_f32 v64, v64
    v_exp_f32 v65, v65
    v_mfma_f32_32x32x16_bf16 v[104:119], v[28:31], v[76:79], v[104:119]
    buffer_load_dwordx4 v[160:163], v3, s[32:35], s13 offen offset:2048
    v_exp_f32 v66, v66
    v_exp_f32 v67, v67
    v_exp_f32 v68, v68
    v_exp_f32 v69, v69
    v_exp_f32 v70, v70
    v_exp_f32 v71, v71
    v_cvt_pk_bf16_f32 v80, v56, v57
    v_cvt_pk_bf16_f32 v81, v58, v59
    v_cvt_pk_bf16_f32 v82, v60, v61
    v_cvt_pk_bf16_f32 v83, v62, v63
    v_cvt_pk_bf16_f32 v84, v64, v65
    v_cvt_pk_bf16_f32 v85, v66, v67
    v_cvt_pk_bf16_f32 v86, v68, v69
    v_cvt_pk_bf16_f32 v87, v70, v71
    s_waitcnt lgkmcnt(0)
    v_mfma_f32_32x32x16_bf16 v[56:71], v[20:23], v[8:11], v[88:103]
    ds_read_b128 v[16:19], v1 offset:20480
    s_mov_b64 exec, s[86:87]
    ds_read_b128 v[24:27], v2 offset:18432
    ds_read_b128 v[28:31], v2 offset:18944
    s_mov_b64 exec, -1
    v_exp_f32 v40, v40
    v_exp_f32 v41, v41
    v_exp_f32 v42, v42
    v_exp_f32 v43, v43
    v_exp_f32 v44, v44
    v_mfma_f32_32x32x16_bf16 v[104:119], v[32:35], v[80:83], v[104:119]
    v_exp_f32 v45, v45
    v_exp_f32 v46, v46
    v_exp_f32 v47, v47
    v_exp_f32 v48, v48
    v_exp_f32 v49, v49
    v_mfma_f32_32x32x16_bf16 v[104:119], v[36:39], v[84:87], v[104:119]
    v_exp_f32 v50, v50
    v_exp_f32 v51, v51
    v_exp_f32 v52, v52
    v_exp_f32 v53, v53
    v_exp_f32 v54, v54
    v_exp_f32 v55, v55
    v_cvt_pk_bf16_f32 v72, v40, v41
    v_cvt_pk_bf16_f32 v73, v42, v43
    v_cvt_pk_bf16_f32 v74, v44, v45
    v_cvt_pk_bf16_f32 v75, v46, v47
    v_cvt_pk_bf16_f32 v76, v48, v49
    v_cvt_pk_bf16_f32 v77, v50, v51
    v_cvt_pk_bf16_f32 v78, v52, v53
    v_cvt_pk_bf16_f32 v79, v54, v55
    s_waitcnt lgkmcnt(0)
    v_mfma_f32_32x32x16_bf16 v[40:55], v[16:19], v[8:11], v[88:103]
    ds_read_b128 v[20:23], v1 offset:21504
    s_mov_b64 exec, s[86:87]
    ds_read_b128 v[32:35], v2 offset:19456
    ds_read_b128 v[36:39], v2 offset:19968
    s_mov_b64 exec, -1
    v_exp_f32 v56, v56
    v_exp_f32 v57, v57
    v_exp_f32 v58, v58
    v_exp_f32 v59, v59
    v_exp_f32 v60, v60
    v_mfma_f32_32x32x16_bf16 v[104:119], v[24:27], v[72:75], v[104:119]
    v_exp_f32 v61, v61
    v_exp_f32 v62, v62
    v_exp_f32 v63, v63
    v_exp_f32 v64, v64
    v_exp_f32 v65, v65
    v_mfma_f32_32x32x16_bf16 v[104:119], v[28:31], v[76:79], v[104:119]
    buffer_load_dwordx4 v[164:167], v3, s[32:35], s13 offen offset:3072
    v_exp_f32 v66, v66
    v_exp_f32 v67, v67
    v_exp_f32 v68, v68
    v_exp_f32 v69, v69
    v_exp_f32 v70, v70
    v_exp_f32 v71, v71
    v_cvt_pk_bf16_f32 v80, v56, v57
    v_cvt_pk_bf16_f32 v81, v58, v59
    v_cvt_pk_bf16_f32 v82, v60, v61
    v_cvt_pk_bf16_f32 v83, v62, v63
    v_cvt_pk_bf16_f32 v84, v64, v65
    v_cvt_pk_bf16_f32 v85, v66, v67
    v_cvt_pk_bf16_f32 v86, v68, v69
    v_cvt_pk_bf16_f32 v87, v70, v71
    s_waitcnt lgkmcnt(0)
    v_mfma_f32_32x32x16_bf16 v[56:71], v[20:23], v[8:11], v[88:103]
    ds_read_b128 v[16:19], v1 offset:22528
    s_mov_b64 exec, s[86:87]
    ds_read_b128 v[24:27], v2 offset:20480
    ds_read_b128 v[28:31], v2 offset:20992
    s_mov_b64 exec, -1
    v_exp_f32 v40, v40
    v_exp_f32 v41, v41
    v_exp_f32 v42, v42
    v_exp_f32 v43, v43
    v_exp_f32 v44, v44
    v_mfma_f32_32x32x16_bf16 v[104:119], v[32:35], v[80:83], v[104:119]
    v_exp_f32 v45, v45
    v_exp_f32 v46, v46
    v_exp_f32 v47, v47
    v_exp_f32 v48, v48
    v_exp_f32 v49, v49
    v_mfma_f32_32x32x16_bf16 v[104:119], v[36:39], v[84:87], v[104:119]
    v_exp_f32 v50, v50
    v_exp_f32 v51, v51
    v_exp_f32 v52, v52
    v_exp_f32 v53, v53
    v_exp_f32 v54, v54
    v_exp_f32 v55, v55
    v_cvt_pk_bf16_f32 v72, v40, v41
    v_cvt_pk_bf16_f32 v73, v42, v43
    v_cvt_pk_bf16_f32 v74, v44, v45
    v_cvt_pk_bf16_f32 v75, v46, v47
    v_cvt_pk_bf16_f32 v76, v48, v49
    v_cvt_pk_bf16_f32 v77, v50, v51
    v_cvt_pk_bf16_f32 v78, v52, v53
    v_cvt_pk_bf16_f32 v79, v54, v55
    s_waitcnt lgkmcnt(0)
    v_mfma_f32_32x32x16_bf16 v[40:55], v[16:19], v[8:11], v[88:103]
    ds_read_b128 v[20:23], v1 offset:23552
    s_mov_b64 exec, s[86:87]
    ds_read_b128 v[32:35], v2 offset:21504
    ds_read_b128 v[36:39], v2 offset:22016
    s_mov_b64 exec, -1
    v_exp_f32 v56, v56
    v_exp_f32 v57, v57
    v_exp_f32 v58, v58
    v_exp_f32 v59, v59
    v_exp_f32 v60, v60
    v_mfma_f32_32x32x16_bf16 v[104:119], v[24:27], v[72:75], v[104:119]
    v_exp_f32 v61, v61
    v_exp_f32 v62, v62
    v_exp_f32 v63, v63
    v_exp_f32 v64, v64
    v_exp_f32 v65, v65
    v_mfma_f32_32x32x16_bf16 v[104:119], v[28:31], v[76:79], v[104:119]
    s_add_u32 s13, s13, 4096
    buffer_load_dwordx4 v[168:171], v3, s[32:35], s13 offen offset:0
    v_exp_f32 v66, v66
    v_exp_f32 v67, v67
    v_exp_f32 v68, v68
    v_exp_f32 v69, v69
    v_exp_f32 v70, v70
    v_exp_f32 v71, v71
    v_cvt_pk_bf16_f32 v80, v56, v57
    v_cvt_pk_bf16_f32 v81, v58, v59
    v_cvt_pk_bf16_f32 v82, v60, v61
    v_cvt_pk_bf16_f32 v83, v62, v63
    v_cvt_pk_bf16_f32 v84, v64, v65
    v_cvt_pk_bf16_f32 v85, v66, v67
    v_cvt_pk_bf16_f32 v86, v68, v69
    v_cvt_pk_bf16_f32 v87, v70, v71
    s_waitcnt lgkmcnt(0)
    v_mfma_f32_32x32x16_bf16 v[56:71], v[20:23], v[8:11], v[88:103]
    ds_read_b128 v[16:19], v1 offset:24576
    s_mov_b64 exec, s[86:87]
    ds_read_b128 v[24:27], v2 offset:22528
    ds_read_b128 v[28:31], v2 offset:23040
    s_mov_b64 exec, -1
    v_exp_f32 v40, v40
    v_exp_f32 v41, v41
    v_exp_f32 v42, v42
    v_exp_f32 v43, v43
    v_exp_f32 v44, v44
    v_mfma_f32_32x32x16_bf16 v[104:119], v[32:35], v[80:83], v[104:119]
    v_exp_f32 v45, v45
    v_exp_f32 v46, v46
    v_exp_f32 v47, v47
    v_exp_f32 v48, v48
    v_exp_f32 v49, v49
    v_mfma_f32_32x32x16_bf16 v[104:119], v[36:39], v[84:87], v[104:119]
    v_exp_f32 v50, v50
    v_exp_f32 v51, v51
    v_exp_f32 v52, v52
    v_exp_f32 v53, v53
    v_exp_f32 v54, v54
    v_exp_f32 v55, v55
    v_cvt_pk_bf16_f32 v72, v40, v41
    v_cvt_pk_bf16_f32 v73, v42, v43
    v_cvt_pk_bf16_f32 v74, v44, v45
    v_cvt_pk_bf16_f32 v75, v46, v47
    v_cvt_pk_bf16_f32 v76, v48, v49
    v_cvt_pk_bf16_f32 v77, v50, v51
    v_cvt_pk_bf16_f32 v78, v52, v53
    v_cvt_pk_bf16_f32 v79, v54, v55
    s_waitcnt lgkmcnt(0)
    v_mfma_f32_32x32x16_bf16 v[40:55], v[16:19], v[8:11], v[88:103]
    ds_read_b128 v[20:23], v1 offset:25600
    s_mov_b64 exec, s[86:87]
    ds_read_b128 v[32:35], v2 offset:23552
    ds_read_b128 v[36:39], v2 offset:24064
    s_mov_b64 exec, -1
    v_exp_f32 v56, v56
    v_exp_f32 v57, v57
    v_exp_f32 v58, v58
    v_exp_f32 v59, v59
    v_exp_f32 v60, v60
    v_mfma_f32_32x32x16_bf16 v[104:119], v[24:27], v[72:75], v[104:119]
    v_exp_f32 v61, v61
    v_exp_f32 v62, v62
    v_exp_f32 v63, v63
    v_exp_f32 v64, v64
    v_exp_f32 v65, v65
    v_mfma_f32_32x32x16_bf16 v[104:119], v[28:31], v[76:79], v[104:119]
    buffer_load_dwordx4 v[172:175], v3, s[32:35], s13 offen offset:1024
    v_exp_f32 v66, v66
    v_exp_f32 v67, v67
    v_exp_f32 v68, v68
    v_exp_f32 v69, v69
    v_exp_f32 v70, v70
    v_exp_f32 v71, v71
    v_cvt_pk_bf16_f32 v80, v56, v57
    v_cvt_pk_bf16_f32 v81, v58, v59
    v_cvt_pk_bf16_f32 v82, v60, v61
    v_cvt_pk_bf16_f32 v83, v62, v63
    v_cvt_pk_bf16_f32 v84, v64, v65
    v_cvt_pk_bf16_f32 v85, v66, v67
    v_cvt_pk_bf16_f32 v86, v68, v69
    v_cvt_pk_bf16_f32 v87, v70, v71
    s_waitcnt lgkmcnt(0)
    v_mfma_f32_32x32x16_bf16 v[56:71], v[20:23], v[8:11], v[88:103]
    ds_read_b128 v[16:19], v1 offset:26624
    s_mov_b64 exec, s[86:87]
    ds_read_b128 v[24:27], v2 offset:24576
    ds_read_b128 v[28:31], v2 offset:25088
    s_mov_b64 exec, -1
    v_exp_f32 v40, v40
    v_exp_f32 v41, v41
    v_exp_f32 v42, v42
    v_exp_f32 v43, v43
    v_exp_f32 v44, v44
    v_mfma_f32_32x32x16_bf16 v[104:119], v[32:35], v[80:83], v[104:119]
    v_exp_f32 v45, v45
    v_exp_f32 v46, v46
    v_exp_f32 v47, v47
    v_exp_f32 v48, v48
    v_exp_f32 v49, v49
    v_mfma_f32_32x32x16_bf16 v[104:119], v[36:39], v[84:87], v[104:119]
    v_exp_f32 v50, v50
    v_exp_f32 v51, v51
    v_exp_f32 v52, v52
    v_exp_f32 v53, v53
    v_exp_f32 v54, v54
    v_exp_f32 v55, v55
    v_cvt_pk_bf16_f32 v72, v40, v41
    v_cvt_pk_bf16_f32 v73, v42, v43
    v_cvt_pk_bf16_f32 v74, v44, v45
    v_cvt_pk_bf16_f32 v75, v46, v47
    v_cvt_pk_bf16_f32 v76, v48, v49
    v_cvt_pk_bf16_f32 v77, v50, v51
    v_cvt_pk_bf16_f32 v78, v52, v53
    v_cvt_pk_bf16_f32 v79, v54, v55
    s_waitcnt lgkmcnt(0)
    s_cmp_eq_u32 s94, 2
    s_cbranch_scc1 K2_D0
K2_D0R:
    v_mfma_f32_32x32x16_bf16 v[40:55], v[16:19], v[8:11], v[88:103]
    ds_read_b128 v[20:23], v1 offset:27648
    s_mov_b64 exec, s[86:87]
    ds_read_b128 v[32:35], v2 offset:25600
    ds_read_b128 v[36:39], v2 offset:26112
    s_mov_b64 exec, -1
    v_exp_f32 v56, v56
    v_exp_f32 v57, v57
    v_exp_f32 v58, v58
    v_exp_f32 v59, v59
    v_exp_f32 v60, v60
    v_mfma_f32_32x32x16_bf16 v[104:119], v[24:27], v[72:75], v[104:119]
    v_exp_f32 v61, v61
    v_exp_f32 v62, v62
    v_exp_f32 v63, v63
    v_exp_f32 v64, v64
    v_exp_f32 v65, v65
    v_mfma_f32_32x32x16_bf16 v[104:119], v[28:31], v[76:79], v[104:119]
    buffer_load_dwordx4 v[176:179], v3, s[32:35], s13 offen offset:2048
    v_exp_f32 v66, v66
    v_exp_f32 v67, v67
    v_exp_f32 v68, v68
    v_exp_f32 v69, v69
    v_exp_f32 v70, v70
    v_exp_f32 v71, v71
    v_cvt_pk_bf16_f32 v80, v56, v57
    v_cvt_pk_bf16_f32 v81, v58, v59
    v_cvt_pk_bf16_f32 v82, v60, v61
    v_cvt_pk_bf16_f32 v83, v62, v63
    v_cvt_pk_bf16_f32 v84, v64, v65
    v_cvt_pk_bf16_f32 v85, v66, v67
    v_cvt_pk_bf16_f32 v86, v68, v69
    v_cvt_pk_bf16_f32 v87, v70, v71
    s_waitcnt lgkmcnt(0)
    v_mfma_f32_32x32x16_bf16 v[56:71], v[20:23], v[8:11], v[88:103]
    ds_read_b128 v[16:19], v1 offset:28672
    s_mov_b64 exec, s[86:87]
    ds_read_b128 v[24:27], v2 offset:26624
    ds_read_b128 v[28:31], v2 offset:27136
    s_mov_b64 exec, -1
    v_exp_f32 v40, v40
    v_exp_f32 v41, v41
    v_exp_f32 v42, v42
    v_exp_f32 v43, v43
    v_exp_f32 v44, v44
    v_mfma_f32_32x32x16_bf16 v[104:119], v[32:35], v[80:83], v[104:119]
    v_exp_f32 v45, v45
    v_exp_f32 v46, v46
    v_exp_f32 v47, v47
    v_exp_f32 v48, v48
    v_exp_f32 v49, v49
    v_mfma_f32_32x32x16_bf16 v[104:119], v[36:39], v[84:87], v[104:119]
    v_exp_f32 v50, v50
    v_exp_f32 v51, v51
    v_exp_f32 v52, v52
    v_exp_f32 v53, v53
    v_exp_f32 v54, v54
    v_exp_f32 v55, v55
    v_cvt_pk_bf16_f32 v72, v40, v41
    v_cvt_pk_bf16_f32 v73, v42, v43
    v_cvt_pk_bf16_f32 v74, v44, v45
    v_cvt_pk_bf16_f32 v75, v46, v47
    v_cvt_pk_bf16_f32 v76, v48, v49
    v_cvt_pk_bf16_f32 v77, v50, v51
    v_cvt_pk_bf16_f32 v78, v52, v53
    v_cvt_pk_bf16_f32 v79, v54, v55
    s_waitcnt lgkmcnt(0)
    v_mfma_f32_32x32x16_bf16 v[40:55], v[16:19], v[8:11], v[88:103]
    ds_read_b128 v[20:23], v1 offset:29696
    s_mov_b64 exec, s[86:87]
    ds_read_b128 v[32:35], v2 offset:27648
    ds_read_b128 v[36:39], v2 offset:28160
    s_mov_b64 exec, -1
    v_exp_f32 v56, v56
    v_exp_f32 v57, v57
    v_exp_f32 v58, v58
    v_exp_f32 v59, v59
    v_exp_f32 v60, v60
    v_mfma_f32_32x32x16_bf16 v[104:119], v[24:27], v[72:75], v[104:119]
    v_exp_f32 v61, v61
    v_exp_f32 v62, v62
    v_exp_f32 v63, v63
    v_exp_f32 v64, v64
    v_exp_f32 v65, v65
    v_mfma_f32_32x32x16_bf16 v[104:119], v[28:31], v[76:79], v[104:119]
    buffer_load_dwordx4 v[180:183], v3, s[32:35], s13 offen offset:3072
    v_exp_f32 v66, v66
    v_exp_f32 v67, v67
    v_exp_f32 v68, v68
    v_exp_f32 v69, v69
    v_exp_f32 v70, v70
    v_exp_f32 v71, v71
    v_cvt_pk_bf16_f32 v80, v56, v57
    v_cvt_pk_bf16_f32 v81, v58, v59
    v_cvt_pk_bf16_f32 v82, v60, v61
    v_cvt_pk_bf16_f32 v83, v62, v63
    v_cvt_pk_bf16_f32 v84, v64, v65
    v_cvt_pk_bf16_f32 v85, v66, v67
    v_cvt_pk_bf16_f32 v86, v68, v69
    v_cvt_pk_bf16_f32 v87, v70, v71
    s_waitcnt lgkmcnt(0)
    s_cmp_eq_u32 s94, 2
    s_cbranch_scc1 K2_D1
K2_D1R:
    v_mfma_f32_32x32x16_bf16 v[56:71], v[20:23], v[8:11], v[88:103]
    ds_read_b128 v[16:19], v1 offset:30720
    s_mov_b64 exec, s[86:87]
    ds_read_b128 v[24:27], v2 offset:28672
    ds_read_b128 v[28:31], v2 offset:29184
    s_mov_b64 exec, -1
    v_exp_f32 v40, v40
    v_exp_f32 v41, v41
    v_exp_f32 v42, v42
    v_exp_f32 v43, v43
    v_exp_f32 v44, v44
    v_mfma_f32_32x32x16_bf16 v[104:119], v[32:35], v[80:83], v[104:119]
    v_exp_f32 v45, v45
    v_exp_f32 v46, v46
    v_exp_f32 v47, v47
    v_exp_f32 v48, v48
    v_exp_f32 v49, v49
    v_mfma_f32_32x32x16_bf16 v[104:119], v[36:39], v[84:87], v[104:119]
    v_exp_f32 v50, v50
    v_exp_f32 v51, v51
    v_exp_f32 v52, v52
    v_exp_f32 v53, v53
    v_exp_f32 v54, v54
    v_exp_f32 v55, v55
    v_cvt_pk_bf16_f32 v72, v40, v41
    v_cvt_pk_bf16_f32 v73, v42, v43
    v_cvt_pk_bf16_f32 v74, v44, v45
    v_cvt_pk_bf16_f32 v75, v46, v47
    v_cvt_pk_bf16_f32 v76, v48, v49
    v_cvt_pk_bf16_f32 v77, v50, v51
    v_cvt_pk_bf16_f32 v78, v52, v53
    v_cvt_pk_bf16_f32 v79, v54, v55
    s_waitcnt lgkmcnt(0)
    v_mfma_f32_32x32x16_bf16 v[40:55], v[16:19], v[8:11], v[88:103]
    ds_read_b128 v[20:23], v1 offset:31744
    s_mov_b64 exec, s[86:87]
    ds_read_b128 v[32:35], v2 offset:29696
    ds_read_b128 v[36:39], v2 offset:30208
    s_mov_b64 exec, -1
    v_exp_f32 v56, v56
    v_exp_f32 v57, v57
    v_exp_f32 v58, v58
    v_exp_f32 v59, v59
    v_exp_f32 v60, v60
    v_mfma_f32_32x32x16_bf16 v[104:119], v[24:27], v[72:75], v[104:119]
    v_exp_f32 v61, v61
    v_exp_f32 v62, v62
    v_exp_f32 v63, v63
    v_exp_f32 v64, v64
    v_exp_f32 v65, v65
    v_mfma_f32_32x32x16_bf16 v[104:119], v[28:31], v[76:79], v[104:119]
    s_add_u32 s13, s13, 4096
    buffer_load_dwordx4 v[184:187], v3, s[32:35], s13 offen offset:0
    v_exp_f32 v66, v66
    v_exp_f32 v67, v67
    v_exp_f32 v68, v68
    v_exp_f32 v69, v69
    v_exp_f32 v70, v70
    v_exp_f32 v71, v71
    v_cvt_pk_bf16_f32 v80, v56, v57
    v_cvt_pk_bf16_f32 v81, v58, v59
    v_cvt_pk_bf16_f32 v82, v60, v61
    v_cvt_pk_bf16_f32 v83, v62, v63
    v_cvt_pk_bf16_f32 v84, v64, v65
    v_cvt_pk_bf16_f32 v85, v66, v67
    v_cvt_pk_bf16_f32 v86, v68, v69
    v_cvt_pk_bf16_f32 v87, v70, v71
    s_waitcnt lgkmcnt(0)
    v_mfma_f32_32x32x16_bf16 v[56:71], v[20:23], v[8:11], v[88:103]
    ds_read_b128 v[16:19], v1 offset:32768
    s_mov_b64 exec, s[86:87]
    ds_read_b128 v[24:27], v2 offset:30720
    ds_read_b128 v[28:31], v2 offset:31232
    s_mov_b64 exec, -1
    v_exp_f32 v40, v40
    v_exp_f32 v41, v41
    v_exp_f32 v42, v42
    v_exp_f32 v43, v43
    v_exp_f32 v44, v44
    v_mfma_f32_32x32x16_bf16 v[104:119], v[32:35], v[80:83], v[104:119]
    v_exp_f32 v45, v45
    v_exp_f32 v46, v46
    v_exp_f32 v47, v47
    v_exp_f32 v48, v48
    v_exp_f32 v49, v49
    v_mfma_f32_32x32x16_bf16 v[104:119], v[36:39], v[84:87], v[104:119]
    v_exp_f32 v50, v50
    v_exp_f32 v51, v51
    v_exp_f32 v52, v52
    v_exp_f32 v53, v53
    v_exp_f32 v54, v54
    v_exp_f32 v55, v55
    v_cvt_pk_bf16_f32 v72, v40, v41
    v_cvt_pk_bf16_f32 v73, v42, v43
    v_cvt_pk_bf16_f32 v74, v44, v45
    v_cvt_pk_bf16_f32 v75, v46, v47
    v_cvt_pk_bf16_f32 v76, v48, v49
    v_cvt_pk_bf16_f32 v77, v50, v51
    v_cvt_pk_bf16_f32 v78, v52, v53
    v_cvt_pk_bf16_f32 v79, v54, v55
    s_waitcnt lgkmcnt(0)
    s_cmp_eq_u32 s94, 2
    s_cbranch_scc1 K2_D2
K2_D2R:
    v_mfma_f32_32x32x16_bf16 v[40:55], v[16:19], v[8:11], v[88:103]
    ds_read_b128 v[20:23], v1 offset:33792
    s_mov_b64 exec, s[86:87]
    ds_read_b128 v[32:35], v2 offset:31744
    ds_read_b128 v[36:39], v2 offset:32256
    s_mov_b64 exec, -1
    v_exp_f32 v56, v56
    v_exp_f32 v57, v57
    v_exp_f32 v58, v58
    v_exp_f32 v59, v59
    v_exp_f32 v60, v60
    v_mfma_f32_32x32x16_bf16 v[104:119], v[24:27], v[72:75], v[104:119]
    v_exp_f32 v61, v61
    v_exp_f32 v62, v62
    v_exp_f32 v63, v63
    v_exp_f32 v64, v64
    v_exp_f32 v65, v65
    v_mfma_f32_32x32x16_bf16 v[104:119], v[28:31], v[76:79], v[104:119]
    buffer_load_dwordx4 v[188:191], v3, s[32:35], s13 offen offset:1024
    v_exp_f32 v66, v66
    v_exp_f32 v67, v67
    v_exp_f32 v68, v68
    v_exp_f32 v69, v69
    v_exp_f32 v70, v70
    v_exp_f32 v71, v71
    v_cvt_pk_bf16_f32 v80, v56, v57
    v_cvt_pk_bf16_f32 v81, v58, v59
    v_cvt_pk_bf16_f32 v82, v60, v61
    v_cvt_pk_bf16_f32 v83, v62, v63
    v_cvt_pk_bf16_f32 v84, v64, v65
    v_cvt_pk_bf16_f32 v85, v66, v67
    v_cvt_pk_bf16_f32 v86, v68, v69
    v_cvt_pk_bf16_f32 v87, v70, v71
    s_waitcnt lgkmcnt(0)
    v_mfma_f32_32x32x16_bf16 v[56:71], v[20:23], v[8:11], v[88:103]
    ds_read_b128 v[16:19], v1 offset:34816
    s_mov_b64 exec, s[86:87]
    ds_read_b128 v[24:27], v2 offset:32768
    ds_read_b128 v[28:31], v2 offset:33280
    s_mov_b64 exec, -1
    v_exp_f32 v40, v40
    v_exp_f32 v41, v41
    v_exp_f32 v42, v42
    v_exp_f32 v43, v43
    v_exp_f32 v44, v44
    v_mfma_f32_32x32x16_bf16 v[104:119], v[32:35], v[80:83], v[104:119]
    v_exp_f32 v45, v45
    v_exp_f32 v46, v46
    v_exp_f32 v47, v47
    v_exp_f32 v48, v48
    v_exp_f32 v49, v49
    v_mfma_f32_32x32x16_bf16 v[104:119], v[36:39], v[84:87], v[104:119]
    v_exp_f32 v50, v50
    v_exp_f32 v51, v51
    v_exp_f32 v52, v52
    v_exp_f32 v53, v53
    v_exp_f32 v54, v54
    v_exp_f32 v55, v55
    v_cvt_pk_bf16_f32 v72, v40, v41
    v_cvt_pk_bf16_f32 v73, v42, v43
    v_cvt_pk_bf16_f32 v74, v44, v45
    v_cvt_pk_bf16_f32 v75, v46, v47
    v_cvt_pk_bf16_f32 v76, v48, v49
    v_cvt_pk_bf16_f32 v77, v50, v51
    v_cvt_pk_bf16_f32 v78, v52, v53
    v_cvt_pk_bf16_f32 v79, v54, v55
    s_waitcnt lgkmcnt(0)
    v_mfma_f32_32x32x16_bf16 v[40:55], v[16:19], v[8:11], v[88:103]
    ds_read_b128 v[20:23], v1 offset:35840
    s_mov_b64 exec, s[86:87]
    ds_read_b128 v[32:35], v2 offset:33792
    ds_read_b128 v[36:39], v2 offset:34304
    s_mov_b64 exec, -1
    v_exp_f32 v56, v56
    v_exp_f32 v57, v57
    v_exp_f32 v58, v58
    v_exp_f32 v59, v59
    v_exp_f32 v60, v60
    v_mfma_f32_32x32x16_bf16 v[104:119], v[24:27], v[72:75], v[104:119]
    v_exp_f32 v61, v61
    v_exp_f32 v62, v62
    v_exp_f32 v63, v63
    v_exp_f32 v64, v64
    v_exp_f32 v65, v65
    v_mfma_f32_32x32x16_bf16 v[104:119], v[28:31], v[76:79], v[104:119]
    buffer_load_dwordx4 v[192:195], v3, s[32:35], s13 offen offset:2048
    v_exp_f32 v66, v66
    v_exp_f32 v67, v67
    v_exp_f32 v68, v68
    v_exp_f32 v69, v69
    v_exp_f32 v70, v70
    v_exp_f32 v71, v71
    v_cvt_pk_bf16_f32 v80, v56, v57
    v_cvt_pk_bf16_f32 v81, v58, v59
    v_cvt_pk_bf16_f32 v82, v60, v61
    v_cvt_pk_bf16_f32 v83, v62, v63
    v_cvt_pk_bf16_f32 v84, v64, v65
    v_cvt_pk_bf16_f32 v85, v66, v67
    v_cvt_pk_bf16_f32 v86, v68, v69
    v_cvt_pk_bf16_f32 v87, v70, v71
    s_waitcnt lgkmcnt(0)
    v_mfma_f32_32x32x16_bf16 v[56:71], v[20:23], v[8:11], v[88:103]
    ds_read_b128 v[16:19], v1 offset:36864
    s_mov_b64 exec, s[86:87]
    ds_read_b128 v[24:27], v2 offset:34816
    ds_read_b128 v[28:31], v2 offset:35328
    s_mov_b64 exec, -1
    v_exp_f32 v40, v40
    v_exp_f32 v41, v41
    v_exp_f32 v42, v42
    v_exp_f32 v43, v43
    v_exp_f32 v44, v44
    v_mfma_f32_32x32x16_bf16 v[104:119], v[32:35], v[80:83], v[104:119]
    v_exp_f32 v45, v45
    v_exp_f32 v46, v46
    v_exp_f32 v47, v47
    v_exp_f32 v48, v48
    v_exp_f32 v49, v49
    v_mfma_f32_32x32x16_bf16 v[104:119], v[36:39], v[84:87], v[104:119]
    v_exp_f32 v50, v50
    v_exp_f32 v51, v51
    v_exp_f32 v52, v52
    v_exp_f32 v53, v53
    v_exp_f32 v54, v54
    v_exp_f32 v55, v55
    v_cvt_pk_bf16_f32 v72, v40, v41
    v_cvt_pk_bf16_f32 v73, v42, v43
    v_cvt_pk_bf16_f32 v74, v44, v45
    v_cvt_pk_bf16_f32 v75, v46, v47
    v_cvt_pk_bf16_f32 v76, v48, v49
    v_cvt_pk_bf16_f32 v77, v50, v51
    v_cvt_pk_bf16_f32 v78, v52, v53
    v_cvt_pk_bf16_f32 v79, v54, v55
    s_waitcnt lgkmcnt(0)
    v_mfma_f32_32x32x16_bf16 v[40:55], v[16:19], v[8:11], v[88:103]
    ds_read_b128 v[20:23], v1 offset:37888
    s_mov_b64 exec, s[86:87]
    ds_read_b128 v[32:35], v2 offset:35840
    ds_read_b128 v[36:39], v2 offset:36352
    s_mov_b64 exec, -1
    v_exp_f32 v56, v56
    v_exp_f32 v57, v57
    v_exp_f32 v58, v58
    v_exp_f32 v59, v59
    v_exp_f32 v60, v60
    v_mfma_f32_32x32x16_bf16 v[104:119], v[24:27], v[72:75], v[104:119]
    v_exp_f32 v61, v61
    v_exp_f32 v62, v62
    v_exp_f32 v63, v63
    v_exp_f32 v64, v64
    v_exp_f32 v65, v65
    v_mfma_f32_32x32x16_bf16 v[104:119], v[28:31], v[76:79], v[104:119]
    buffer_load_dwordx4 v[196:199], v3, s[32:35], s13 offen offset:3072
    v_exp_f32 v66, v66
    v_exp_f32 v67, v67
    v_exp_f32 v68, v68
    v_exp_f32 v69, v69
    v_exp_f32 v70, v70
    v_exp_f32 v71, v71
    v_cvt_pk_bf16_f32 v80, v56, v57
    v_cvt_pk_bf16_f32 v81, v58, v59
    v_cvt_pk_bf16_f32 v82, v60, v61
    v_cvt_pk_bf16_f32 v83, v62, v63
    v_cvt_pk_bf16_f32 v84, v64, v65
    v_cvt_pk_bf16_f32 v85, v66, v67
    v_cvt_pk_bf16_f32 v86, v68, v69
    v_cvt_pk_bf16_f32 v87, v70, v71
    s_waitcnt lgkmcnt(0)
    v_mfma_f32_32x32x16_bf16 v[56:71], v[20:23], v[8:11], v[88:103]
    ds_read_b128 v[16:19], v1 offset:38912
    s_mov_b64 exec, s[86:87]
    ds_read_b128 v[24:27], v2 offset:36864
    ds_read_b128 v[28:31], v2 offset:37376
    s_mov_b64 exec, -1
    v_exp_f32 v40, v40
    v_exp_f32 v41, v41
    v_exp_f32 v42, v42
    v_exp_f32 v43, v43
    v_exp_f32 v44, v44
    v_mfma_f32_32x32x16_bf16 v[104:119], v[32:35], v[80:83], v[104:119]
    v_exp_f32 v45, v45
    v_exp_f32 v46, v46
    v_exp_f32 v47, v47
    v_exp_f32 v48, v48
    v_exp_f32 v49, v49
    v_mfma_f32_32x32x16_bf16 v[104:119], v[36:39], v[84:87], v[104:119]
    v_exp_f32 v50, v50
    v_exp_f32 v51, v51
    v_exp_f32 v52, v52
    v_exp_f32 v53, v53
    v_exp_f32 v54, v54
    v_exp_f32 v55, v55
    v_cvt_pk_bf16_f32 v72, v40, v41
    v_cvt_pk_bf16_f32 v73, v42, v43
    v_cvt_pk_bf16_f32 v74, v44, v45
    v_cvt_pk_bf16_f32 v75, v46, v47
    v_cvt_pk_bf16_f32 v76, v48, v49
    v_cvt_pk_bf16_f32 v77, v50, v51
    v_cvt_pk_bf16_f32 v78, v52, v53
    v_cvt_pk_bf16_f32 v79, v54, v55
    s_waitcnt lgkmcnt(0)
    v_mfma_f32_32x32x16_bf16 v[40:55], v[16:19], v[8:11], v[88:103]
    ds_read_b128 v[20:23], v1 offset:39936
    s_mov_b64 exec, s[86:87]
    ds_read_b128 v[32:35], v2 offset:37888
    ds_read_b128 v[36:39], v2 offset:38400
    s_mov_b64 exec, -1
    v_exp_f32 v56, v56
    v_exp_f32 v57, v57
    v_exp_f32 v58, v58
    v_exp_f32 v59, v59
    v_exp_f32 v60, v60
    v_mfma_f32_32x32x16_bf16 v[104:119], v[24:27], v[72:75], v[104:119]
    v_exp_f32 v61, v61
    v_exp_f32 v62, v62
    v_exp_f32 v63, v63
    v_exp_f32 v64, v64
    v_exp_f32 v65, v65
    v_mfma_f32_32x32x16_bf16 v[104:119], v[28:31], v[76:79], v[104:119]
    s_add_u32 s13, s13, 4096
    buffer_load_dwordx4 v[200:203], v3, s[32:35], s13 offen offset:0
    v_exp_f32 v66, v66
    v_exp_f32 v67, v67
    v_exp_f32 v68, v68
    v_exp_f32 v69, v69
    v_exp_f32 v70, v70
    v_exp_f32 v71, v71
    v_cvt_pk_bf16_f32 v80, v56, v57
    v_cvt_pk_bf16_f32 v81, v58, v59
    v_cvt_pk_bf16_f32 v82, v60, v61
    v_cvt_pk_bf16_f32 v83, v62, v63
    v_cvt_pk_bf16_f32 v84, v64, v65
    v_cvt_pk_bf16_f32 v85, v66, v67
    v_cvt_pk_bf16_f32 v86, v68, v69
    v_cvt_pk_bf16_f32 v87, v70, v71
    s_waitcnt lgkmcnt(0)
    v_mfma_f32_32x32x16_bf16 v[56:71], v[20:23], v[8:11], v[88:103]
    ds_read_b128 v[16:19], v1 offset:40960
    s_mov_b64 exec, s[86:87]
    ds_read_b128 v[24:27], v2 offset:38912
    ds_read_b128 v[28:31], v2 offset:39424
    s_mov_b64 exec, -1
    v_exp_f32 v40, v40
    v_exp_f32 v41, v41
    v_exp_f32 v42, v42
    v_exp_f32 v43, v43
    v_exp_f32 v44, v44
    v_mfma_f32_32x32x16_bf16 v[104:119], v[32:35], v[80:83], v[104:119]
    v_exp_f32 v45, v45
    v_exp_f32 v46, v46
    v_exp_f32 v47, v47
    v_exp_f32 v48, v48
    v_exp_f32 v49, v49
    v_mfma_f32_32x32x16_bf16 v[104:119], v[36:39], v[84:87], v[104:119]
    v_exp_f32 v50, v50
    v_exp_f32 v51, v51
    v_exp_f32 v52, v52
    v_exp_f32 v53, v53
    v_exp_f32 v54, v54
    v_exp_f32 v55, v55
    v_cvt_pk_bf16_f32 v72, v40, v41
    v_cvt_pk_bf16_f32 v73, v42, v43
    v_cvt_pk_bf16_f32 v74, v44, v45
    v_cvt_pk_bf16_f32 v75, v46, v47
    v_cvt_pk_bf16_f32 v76, v48, v49
    v_cvt_pk_bf16_f32 v77, v50, v51
    v_cvt_pk_bf16_f32 v78, v52, v53
    v_cvt_pk_bf16_f32 v79, v54, v55
    s_waitcnt lgkmcnt(0)
    v_mfma_f32_32x32x16_bf16 v[40:55], v[16:19], v[8:11], v[88:103]
    ds_read_b128 v[20:23], v1 offset:41984
    s_mov_b64 exec, s[86:87]
    ds_read_b128 v[32:35], v2 offset:39936
    ds_read_b128 v[36:39], v2 offset:40448
    s_mov_b64 exec, -1
    v_exp_f32 v56, v56
    v_exp_f32 v57, v57
    v_exp_f32 v58, v58
    v_exp_f32 v59, v59
    v_exp_f32 v60, v60
    v_mfma_f32_32x32x16_bf16 v[104:119], v[24:27], v[72:75], v[104:119]
    v_exp_f32 v61, v61
    v_exp_f32 v62, v62
    v_exp_f32 v63, v63
    v_exp_f32 v64, v64
    v_exp_f32 v65, v65
    v_mfma_f32_32x32x16_bf16 v[104:119], v[28:31], v[76:79], v[104:119]
    buffer_load_dwordx4 v[204:207], v3, s[32:35], s13 offen offset:1024
    v_exp_f32 v66, v66
    v_exp_f32 v67, v67
    v_exp_f32 v68, v68
    v_exp_f32 v69, v69
    v_exp_f32 v70, v70
    v_exp_f32 v71, v71
    v_cvt_pk_bf16_f32 v80, v56, v57
    v_cvt_pk_bf16_f32 v81, v58, v59
    v_cvt_pk_bf16_f32 v82, v60, v61
    v_cvt_pk_bf16_f32 v83, v62, v63
    v_cvt_pk_bf16_f32 v84, v64, v65
    v_cvt_pk_bf16_f32 v85, v66, v67
    v_cvt_pk_bf16_f32 v86, v68, v69
    v_cvt_pk_bf16_f32 v87, v70, v71
    s_waitcnt lgkmcnt(0)
    v_mfma_f32_32x32x16_bf16 v[56:71], v[20:23], v[8:11], v[88:103]
    ds_read_b128 v[16:19], v1 offset:43008
    s_mov_b64 exec, s[86:87]
    ds_read_b128 v[24:27], v2 offset:40960
    ds_read_b128 v[28:31], v2 offset:41472
    s_mov_b64 exec, -1
    v_exp_f32 v40, v40
    v_exp_f32 v41, v41
    v_exp_f32 v42, v42
    v_exp_f32 v43, v43
    v_exp_f32 v44, v44
    v_mfma_f32_32x32x16_bf16 v[104:119], v[32:35], v[80:83], v[104:119]
    v_exp_f32 v45, v45
    v_exp_f32 v46, v46
    v_exp_f32 v47, v47
    v_exp_f32 v48, v48
    v_exp_f32 v49, v49
    v_mfma_f32_32x32x16_bf16 v[104:119], v[36:39], v[84:87], v[104:119]
    v_exp_f32 v50, v50
    v_exp_f32 v51, v51
    v_exp_f32 v52, v52
    v_exp_f32 v53, v53
    v_exp_f32 v54, v54
    v_exp_f32 v55, v55
    v_cvt_pk_bf16_f32 v72, v40, v41
    v_cvt_pk_bf16_f32 v73, v42, v43
    v_cvt_pk_bf16_f32 v74, v44, v45
    v_cvt_pk_bf16_f32 v75, v46, v47
    v_cvt_pk_bf16_f32 v76, v48, v49
    v_cvt_pk_bf16_f32 v77, v50, v51
    v_cvt_pk_bf16_f32 v78, v52, v53
    v_cvt_pk_bf16_f32 v79, v54, v55
    s_waitcnt lgkmcnt(0)
    s_cmp_eq_u32 s94, 3
    s_cbranch_scc1 K2_SIG2
K2_SIG2R:
    v_mfma_f32_32x32x16_bf16 v[40:55], v[16:19], v[8:11], v[88:103]
    ds_read_b128 v[20:23], v1 offset:44032
    s_mov_b64 exec, s[86:87]
    ds_read_b128 v[32:35], v2 offset:41984
    ds_read_b128 v[36:39], v2 offset:42496
    s_mov_b64 exec, -1
    v_exp_f32 v56, v56
    v_exp_f32 v57, v57
    v_exp_f32 v58, v58
    v_exp_f32 v59, v59
    v_exp_f32 v60, v60
    v_mfma_f32_32x32x16_bf16 v[104:119], v[24:27], v[72:75], v[104:119]
    v_exp_f32 v61, v61
    v_exp_f32 v62, v62
    v_exp_f32 v63, v63
    v_exp_f32 v64, v64
    v_exp_f32 v65, v65
    v_mfma_f32_32x32x16_bf16 v[104:119], v[28:31], v[76:79], v[104:119]
    buffer_load_dwordx4 v[208:211], v3, s[32:35], s13 offen offset:2048
    v_exp_f32 v66, v66
    v_exp_f32 v67, v67
    v_exp_f32 v68, v68
    v_exp_f32 v69, v69
    v_exp_f32 v70, v70
    v_exp_f32 v71, v71
    v_cvt_pk_bf16_f32 v80, v56, v57
    v_cvt_pk_bf16_f32 v81, v58, v59
    v_cvt_pk_bf16_f32 v82, v60, v61
    v_cvt_pk_bf16_f32 v83, v62, v63
    v_cvt_pk_bf16_f32 v84, v64, v65
    v_cvt_pk_bf16_f32 v85, v66, v67
    v_cvt_pk_bf16_f32 v86, v68, v69
    v_cvt_pk_bf16_f32 v87, v70, v71
    s_waitcnt lgkmcnt(0)
    v_mfma_f32_32x32x16_bf16 v[56:71], v[20:23], v[8:11], v[88:103]
    ds_read_b128 v[16:19], v1 offset:45056
    s_mov_b64 exec, s[86:87]
    ds_read_b128 v[24:27], v2 offset:43008
    ds_read_b128 v[28:31], v2 offset:43520
    s_mov_b64 exec, -1
    v_exp_f32 v40, v40
    v_exp_f32 v41, v41
    v_exp_f32 v42, v42
    v_exp_f32 v43, v43
    v_exp_f32 v44, v44
    v_mfma_f32_32x32x16_bf16 v[104:119], v[32:35], v[80:83], v[104:119]
    v_exp_f32 v45, v45
    v_exp_f32 v46, v46
    v_exp_f32 v47, v47
    v_exp_f32 v48, v48
    v_exp_f32 v49, v49
    v_mfma_f32_32x32x16_bf16 v[104:119], v[36:39], v[84:87], v[104:119]
    v_exp_f32 v50, v50
    v_exp_f32 v51, v51
    v_exp_f32 v52, v52
    v_exp_f32 v53, v53
    v_exp_f32 v54, v54
    v_exp_f32 v55, v55
    v_cvt_pk_bf16_f32 v72, v40, v41
    v_cvt_pk_bf16_f32 v73, v42, v43
    v_cvt_pk_bf16_f32 v74, v44, v45
    v_cvt_pk_bf16_f32 v75, v46, v47
    v_cvt_pk_bf16_f32 v76, v48, v49
    v_cvt_pk_bf16_f32 v77, v50, v51
    v_cvt_pk_bf16_f32 v78, v52, v53
    v_cvt_pk_bf16_f32 v79, v54, v55
    s_waitcnt lgkmcnt(0)
    v_mfma_f32_32x32x16_bf16 v[40:55], v[16:19], v[8:11], v[88:103]
    ds_read_b128 v[20:23], v1 offset:46080
    s_mov_b64 exec, s[86:87]
    ds_read_b128 v[32:35], v2 offset:44032
    ds_read_b128 v[36:39], v2 offset:44544
    s_mov_b64 exec, -1
    v_exp_f32 v56, v56
    v_exp_f32 v57, v57
    v_exp_f32 v58, v58
    v_exp_f32 v59, v59
    v_exp_f32 v60, v60
    v_mfma_f32_32x32x16_bf16 v[104:119], v[24:27], v[72:75], v[104:119]
    v_exp_f32 v61, v61
    v_exp_f32 v62, v62
    v_exp_f32 v63, v63
    v_exp_f32 v64, v64
    v_exp_f32 v65, v65
    v_mfma_f32_32x32x16_bf16 v[104:119], v[28:31], v[76:79], v[104:119]
    buffer_load_dwordx4 v[212:215], v3, s[32:35], s13 offen offset:3072
    v_exp_f32 v66, v66
    v_exp_f32 v67, v67
    v_exp_f32 v68, v68
    v_exp_f32 v69, v69
    v_exp_f32 v70, v70
    v_exp_f32 v71, v71
    v_cvt_pk_bf16_f32 v80, v56, v57
    v_cvt_pk_bf16_f32 v81, v58, v59
    v_cvt_pk_bf16_f32 v82, v60, v61
    v_cvt_pk_bf16_f32 v83, v62, v63
    v_cvt_pk_bf16_f32 v84, v64, v65
    v_cvt_pk_bf16_f32 v85, v66, v67
    v_cvt_pk_bf16_f32 v86, v68, v69
    v_cvt_pk_bf16_f32 v87, v70, v71
    s_waitcnt lgkmcnt(0)
    v_mfma_f32_32x32x16_bf16 v[56:71], v[20:23], v[8:11], v[88:103]
    ds_read_b128 v[16:19], v1 offset:47104
    s_mov_b64 exec, s[86:87]
    ds_read_b128 v[24:27], v2 offset:45056
    ds_read_b128 v[28:31], v2 offset:45568
    s_mov_b64 exec, -1
    v_exp_f32 v40, v40
    v_exp_f32 v41, v41
    v_exp_f32 v42, v42
    v_exp_f32 v43, v43
    v_exp_f32 v44, v44
    v_mfma_f32_32x32x16_bf16 v[104:119], v[32:35], v[80:83], v[104:119]
    v_exp_f32 v45, v45
    v_exp_f32 v46, v46
    v_exp_f32 v47, v47
    v_exp_f32 v48, v48
    v_exp_f32 v49, v49
    v_mfma_f32_32x32x16_bf16 v[104:119], v[36:39], v[84:87], v[104:119]
    v_exp_f32 v50, v50
    v_exp_f32 v51, v51
    v_exp_f32 v52, v52
    v_exp_f32 v53, v53
    v_exp_f32 v54, v54
    v_exp_f32 v55, v55
    v_cvt_pk_bf16_f32 v72, v40, v41
    v_cvt_pk_bf16_f32 v73, v42, v43
    v_cvt_pk_bf16_f32 v74, v44, v45
    v_cvt_pk_bf16_f32 v75, v46, v47
    v_cvt_pk_bf16_f32 v76, v48, v49
    v_cvt_pk_bf16_f32 v77, v50, v51
    v_cvt_pk_bf16_f32 v78, v52, v53
    v_cvt_pk_bf16_f32 v79, v54, v55
    s_waitcnt lgkmcnt(0)
    v_mfma_f32_32x32x16_bf16 v[40:55], v[16:19], v[8:11], v[88:103]
    ds_read_b128 v[20:23], v1 offset:48128
    s_mov_b64 exec, s[86:87]
    ds_read_b128 v[32:35], v2 offset:46080
    ds_read_b128 v[36:39], v2 offset:46592
    s_mov_b64 exec, -1
    v_exp_f32 v56, v56
    v_exp_f32 v57, v57
    v_exp_f32 v58, v58
    v_exp_f32 v59, v59
    v_exp_f32 v60, v60
    v_mfma_f32_32x32x16_bf16 v[104:119], v[24:27], v[72:75], v[104:119]
    v_exp_f32 v61, v61
    v_exp_f32 v62, v62
    v_exp_f32 v63, v63
    v_exp_f32 v64, v64
    v_exp_f32 v65, v65
    v_mfma_f32_32x32x16_bf16 v[104:119], v[28:31], v[76:79], v[104:119]
    s_add_u32 s13, s13, 4096
    buffer_load_dwordx4 v[216:219], v3, s[32:35], s13 offen offset:0
    v_exp_f32 v66, v66
    v_exp_f32 v67, v67
    v_exp_f32 v68, v68
    v_exp_f32 v69, v69
    v_exp_f32 v70, v70
    v_exp_f32 v71, v71
    v_cvt_pk_bf16_f32 v80, v56, v57
    v_cvt_pk_bf16_f32 v81, v58, v59
    v_cvt_pk_bf16_f32 v82, v60, v61
    v_cvt_pk_bf16_f32 v83, v62, v63
    v_cvt_pk_bf16_f32 v84, v64, v65
    v_cvt_pk_bf16_f32 v85, v66, v67
    v_cvt_pk_bf16_f32 v86, v68, v69
    v_cvt_pk_bf16_f32 v87, v70, v71
    s_waitcnt lgkmcnt(0)
    v_mfma_f32_32x32x16_bf16 v[56:71], v[20:23], v[8:11], v[88:103]
    ds_read_b128 v[16:19], v1 offset:49152
    s_mov_b64 exec, s[86:87]
    ds_read_b128 v[24:27], v2 offset:47104
    ds_read_b128 v[28:31], v2 offset:47616
    s_mov_b64 exec, -1
    v_exp_f32 v40, v40
    v_exp_f32 v41, v41
    v_exp_f32 v42, v42
    v_exp_f32 v43, v43
    v_exp_f32 v44, v44
    v_mfma_f32_32x32x16_bf16 v[104:119], v[32:35], v[80:83], v[104:119]
    v_exp_f32 v45, v45
    v_exp_f32 v46, v46
    v_exp_f32 v47, v47
    v_exp_f32 v48, v48
    v_exp_f32 v49, v49
    v_mfma_f32_32x32x16_bf16 v[104:119], v[36:39], v[84:87], v[104:119]
    v_exp_f32 v50, v50
    v_exp_f32 v51, v51
    v_exp_f32 v52, v52
    v_exp_f32 v53, v53
    v_exp_f32 v54, v54
    v_exp_f32 v55, v55
    v_cvt_pk_bf16_f32 v72, v40, v41
    v_cvt_pk_bf16_f32 v73, v42, v43
    v_cvt_pk_bf16_f32 v74, v44, v45
    v_cvt_pk_bf16_f32 v75, v46, v47
    v_cvt_pk_bf16_f32 v76, v48, v49
    v_cvt_pk_bf16_f32 v77, v50, v51
    v_cvt_pk_bf16_f32 v78, v52, v53
    v_cvt_pk_bf16_f32 v79, v54, v55
    s_waitcnt lgkmcnt(0)
    v_mfma_f32_32x32x16_bf16 v[40:55], v[16:19], v[8:11], v[88:103]
    ds_read_b128 v[20:23], v1 offset:50176
    s_mov_b64 exec, s[86:87]
    ds_read_b128 v[32:35], v2 offset:48128
    ds_read_b128 v[36:39], v2 offset:48640
    s_mov_b64 exec, -1
    v_exp_f32 v56, v56
    v_exp_f32 v57, v57
    v_exp_f32 v58, v58
    v_exp_f32 v59, v59
    v_exp_f32 v60, v60
    v_mfma_f32_32x32x16_bf16 v[104:119], v[24:27], v[72:75], v[104:119]
    v_exp_f32 v61, v61
    v_exp_f32 v62, v62
    v_exp_f32 v63, v63
    v_exp_f32 v64, v64
    v_exp_f32 v65, v65
    v_mfma_f32_32x32x16_bf16 v[104:119], v[28:31], v[76:79], v[104:119]
    buffer_load_dwordx4 v[220:223], v3, s[32:35], s13 offen offset:1024
    v_exp_f32 v66, v66
    v_exp_f32 v67, v67
    v_exp_f32 v68, v68
    v_exp_f32 v69, v69
    v_exp_f32 v70, v70
    v_exp_f32 v71, v71
    v_cvt_pk_bf16_f32 v80, v56, v57
    v_cvt_pk_bf16_f32 v81, v58, v59
    v_cvt_pk_bf16_f32 v82, v60, v61
    v_cvt_pk_bf16_f32 v83, v62, v63
    v_cvt_pk_bf16_f32 v84, v64, v65
    v_cvt_pk_bf16_f32 v85, v66, v67
    v_cvt_pk_bf16_f32 v86, v68, v69
    v_cvt_pk_bf16_f32 v87, v70, v71
    s_waitcnt lgkmcnt(0)
    v_mfma_f32_32x32x16_bf16 v[56:71], v[20:23], v[8:11], v[88:103]
    ds_read_b128 v[16:19], v1 offset:51200
    s_mov_b64 exec, s[86:87]
    ds_read_b128 v[24:27], v2 offset:49152
    ds_read_b128 v[28:31], v2 offset:49664
    s_mov_b64 exec, -1
    v_exp_f32 v40, v40
    v_exp_f32 v41, v41
    v_exp_f32 v42, v42
    v_exp_f32 v43, v43
    v_exp_f32 v44, v44
    v_mfma_f32_32x32x16_bf16 v[104:119], v[32:35], v[80:83], v[104:119]
    v_exp_f32 v45, v45
    v_exp_f32 v46, v46
    v_exp_f32 v47, v47
    v_exp_f32 v48, v48
    v_exp_f32 v49, v49
    v_mfma_f32_32x32x16_bf16 v[104:119], v[36:39], v[84:87], v[104:119]
    v_exp_f32 v50, v50
    v_exp_f32 v51, v51
    v_exp_f32 v52, v52
    v_exp_f32 v53, v53
    v_exp_f32 v54, v54
    v_exp_f32 v55, v55
    v_cvt_pk_bf16_f32 v72, v40, v41
    v_cvt_pk_bf16_f32 v73, v42, v43
    v_cvt_pk_bf16_f32 v74, v44, v45
    v_cvt_pk_bf16_f32 v75, v46, v47
    v_cvt_pk_bf16_f32 v76, v48, v49
    v_cvt_pk_bf16_f32 v77, v50, v51
    v_cvt_pk_bf16_f32 v78, v52, v53
    v_cvt_pk_bf16_f32 v79, v54, v55
    s_waitcnt lgkmcnt(0)
    v_mfma_f32_32x32x16_bf16 v[40:55], v[16:19], v[8:11], v[88:103]
    ds_read_b128 v[20:23], v1 offset:52224
    s_mov_b64 exec, s[86:87]
    ds_read_b128 v[32:35], v2 offset:50176
    ds_read_b128 v[36:39], v2 offset:50688
    s_mov_b64 exec, -1
    v_exp_f32 v56, v56
    v_exp_f32 v57, v57
    v_exp_f32 v58, v58
    v_exp_f32 v59, v59
    v_exp_f32 v60, v60
    v_mfma_f32_32x32x16_bf16 v[104:119], v[24:27], v[72:75], v[104:119]
    v_exp_f32 v61, v61
    v_exp_f32 v62, v62
    v_exp_f32 v63, v63
    v_exp_f32 v64, v64
    v_exp_f32 v65, v65
    v_mfma_f32_32x32x16_bf16 v[104:119], v[28:31], v[76:79], v[104:119]
    buffer_load_dwordx4 v[224:227], v3, s[32:35], s13 offen offset:2048
    v_exp_f32 v66, v66
    v_exp_f32 v67, v67
    v_exp_f32 v68, v68
    v_exp_f32 v69, v69
    v_exp_f32 v70, v70
    v_exp_f32 v71, v71
    v_cvt_pk_bf16_f32 v80, v56, v57
    v_cvt_pk_bf16_f32 v81, v58, v59
    v_cvt_pk_bf16_f32 v82, v60, v61
    v_cvt_pk_bf16_f32 v83, v62, v63
    v_cvt_pk_bf16_f32 v84, v64, v65
    v_cvt_pk_bf16_f32 v85, v66, v67
    v_cvt_pk_bf16_f32 v86, v68, v69
    v_cvt_pk_bf16_f32 v87, v70, v71
    s_waitcnt lgkmcnt(0)
    v_mfma_f32_32x32x16_bf16 v[56:71], v[20:23], v[8:11], v[88:103]
    ds_read_b128 v[16:19], v1 offset:53248
    s_mov_b64 exec, s[86:87]
    ds_read_b128 v[24:27], v2 offset:51200
    ds_read_b128 v[28:31], v2 offset:51712
    s_mov_b64 exec, -1
    v_exp_f32 v40, v40
    v_exp_f32 v41, v41
    v_exp_f32 v42, v42
    v_exp_f32 v43, v43
    v_exp_f32 v44, v44
    v_mfma_f32_32x32x16_bf16 v[104:119], v[32:35], v[80:83], v[104:119]
    v_exp_f32 v45, v45
    v_exp_f32 v46, v46
    v_exp_f32 v47, v47
    v_exp_f32 v48, v48
    v_exp_f32 v49, v49
    v_mfma_f32_32x32x16_bf16 v[104:119], v[36:39], v[84:87], v[104:119]
    v_exp_f32 v50, v50
    v_exp_f32 v51, v51
    v_exp_f32 v52, v52
    v_exp_f32 v53, v53
    v_exp_f32 v54, v54
    v_exp_f32 v55, v55
    v_cvt_pk_bf16_f32 v72, v40, v41
    v_cvt_pk_bf16_f32 v73, v42, v43
    v_cvt_pk_bf16_f32 v74, v44, v45
    v_cvt_pk_bf16_f32 v75, v46, v47
    v_cvt_pk_bf16_f32 v76, v48, v49
    v_cvt_pk_bf16_f32 v77, v50, v51
    v_cvt_pk_bf16_f32 v78, v52, v53
    v_cvt_pk_bf16_f32 v79, v54, v55
    s_waitcnt lgkmcnt(0)
    v_mfma_f32_32x32x16_bf16 v[40:55], v[16:19], v[8:11], v[88:103]
    ds_read_b128 v[20:23], v1 offset:54272
    s_mov_b64 exec, s[86:87]
    ds_read_b128 v[32:35], v2 offset:52224
    ds_read_b128 v[36:39], v2 offset:52736
    s_mov_b64 exec, -1
    v_exp_f32 v56, v56
    v_exp_f32 v57, v57
    v_exp_f32 v58, v58
    v_exp_f32 v59, v59
    v_exp_f32 v60, v60
    v_mfma_f32_32x32x16_bf16 v[104:119], v[24:27], v[72:75], v[104:119]
    v_exp_f32 v61, v61
    v_exp_f32 v62, v62
    v_exp_f32 v63, v63
    v_exp_f32 v64, v64
    v_exp_f32 v65, v65
    v_mfma_f32_32x32x16_bf16 v[104:119], v[28:31], v[76:79], v[104:119]
    buffer_load_dwordx4 v[228:231], v3, s[32:35], s13 offen offset:3072
    v_exp_f32 v66, v66
    v_exp_f32 v67, v67
    v_exp_f32 v68, v68
    v_exp_f32 v69, v69
    v_exp_f32 v70, v70
    v_exp_f32 v71, v71
    v_cvt_pk_bf16_f32 v80, v56, v57
    v_cvt_pk_bf16_f32 v81, v58, v59
    v_cvt_pk_bf16_f32 v82, v60, v61
    v_cvt_pk_bf16_f32 v83, v62, v63
    v_cvt_pk_bf16_f32 v84, v64, v65
    v_cvt_pk_bf16_f32 v85, v66, v67
    v_cvt_pk_bf16_f32 v86, v68, v69
    v_cvt_pk_bf16_f32 v87, v70, v71
    s_waitcnt lgkmcnt(0)
    v_mfma_f32_32x32x16_bf16 v[56:71], v[20:23], v[8:11], v[88:103]
    ds_read_b128 v[16:19], v1 offset:55296
    s_mov_b64 exec, s[86:87]
    ds_read_b128 v[24:27], v2 offset:53248
    ds_read_b128 v[28:31], v2 offset:53760
    s_mov_b64 exec, -1
    v_exp_f32 v40, v40
    v_exp_f32 v41, v41
    v_exp_f32 v42, v42
    v_exp_f32 v43, v43
    v_exp_f32 v44, v44
    v_mfma_f32_32x32x16_bf16 v[104:119], v[32:35], v[80:83], v[104:119]
    v_exp_f32 v45, v45
    v_exp_f32 v46, v46
    v_exp_f32 v47, v47
    v_exp_f32 v48, v48
    v_exp_f32 v49, v49
    v_mfma_f32_32x32x16_bf16 v[104:119], v[36:39], v[84:87], v[104:119]
    v_exp_f32 v50, v50
    v_exp_f32 v51, v51
    v_exp_f32 v52, v52
    v_exp_f32 v53, v53
    v_exp_f32 v54, v54
    v_exp_f32 v55, v55
    v_cvt_pk_bf16_f32 v72, v40, v41
    v_cvt_pk_bf16_f32 v73, v42, v43
    v_cvt_pk_bf16_f32 v74, v44, v45
    v_cvt_pk_bf16_f32 v75, v46, v47
    v_cvt_pk_bf16_f32 v76, v48, v49
    v_cvt_pk_bf16_f32 v77, v50, v51
    v_cvt_pk_bf16_f32 v78, v52, v53
    v_cvt_pk_bf16_f32 v79, v54, v55
    s_waitcnt lgkmcnt(0)
    v_mfma_f32_32x32x16_bf16 v[40:55], v[16:19], v[8:11], v[88:103]
    ds_read_b128 v[20:23], v1 offset:56320
    s_mov_b64 exec, s[86:87]
    ds_read_b128 v[32:35], v2 offset:54272
    ds_read_b128 v[36:39], v2 offset:54784
    s_mov_b64 exec, -1
    v_exp_f32 v56, v56
    v_exp_f32 v57, v57
    v_exp_f32 v58, v58
    v_exp_f32 v59, v59
    v_exp_f32 v60, v60
    v_mfma_f32_32x32x16_bf16 v[104:119], v[24:27], v[72:75], v[104:119]
    v_exp_f32 v61, v61
    v_exp_f32 v62, v62
    v_exp_f32 v63, v63
    v_exp_f32 v64, v64
    v_exp_f32 v65, v65
    v_mfma_f32_32x32x16_bf16 v[104:119], v[28:31], v[76:79], v[104:119]
    s_add_u32 s13, s13, 4096
    buffer_load_dwordx4 v[232:235], v3, s[32:35], s13 offen offset:0
    v_exp_f32 v66, v66
    v_exp_f32 v67, v67
    v_exp_f32 v68, v68
    v_exp_f32 v69, v69
    v_exp_f32 v70, v70
    v_exp_f32 v71, v71
    v_cvt_pk_bf16_f32 v80, v56, v57
    v_cvt_pk_bf16_f32 v81, v58, v59
    v_cvt_pk_bf16_f32 v82, v60, v61
    v_cvt_pk_bf16_f32 v83, v62, v63
    v_cvt_pk_bf16_f32 v84, v64, v65
    v_cvt_pk_bf16_f32 v85, v66, v67
    v_cvt_pk_bf16_f32 v86, v68, v69
    v_cvt_pk_bf16_f32 v87, v70, v71
    s_waitcnt lgkmcnt(0)
    v_mfma_f32_32x32x16_bf16 v[56:71], v[20:23], v[8:11], v[88:103]
    ds_read_b128 v[16:19], v1 offset:57344
    s_mov_b64 exec, s[86:87]
    ds_read_b128 v[24:27], v2 offset:55296
    ds_read_b128 v[28:31], v2 offset:55808
    s_mov_b64 exec, -1
    v_exp_f32 v40, v40
    v_exp_f32 v41, v41
    v_exp_f32 v42, v42
    v_exp_f32 v43, v43
    v_exp_f32 v44, v44
    v_mfma_f32_32x32x16_bf16 v[104:119], v[32:35], v[80:83], v[104:119]
    v_exp_f32 v45, v45
    v_exp_f32 v46, v46
    v_exp_f32 v47, v47
    v_exp_f32 v48, v48
    v_exp_f32 v49, v49
    v_mfma_f32_32x32x16_bf16 v[104:119], v[36:39], v[84:87], v[104:119]
    v_exp_f32 v50, v50
    v_exp_f32 v51, v51
    v_exp_f32 v52, v52
    v_exp_f32 v53, v53
    v_exp_f32 v54, v54
    v_exp_f32 v55, v55
    v_cvt_pk_bf16_f32 v72, v40, v41
    v_cvt_pk_bf16_f32 v73, v42, v43
    v_cvt_pk_bf16_f32 v74, v44, v45
    v_cvt_pk_bf16_f32 v75, v46, v47
    v_cvt_pk_bf16_f32 v76, v48, v49
    v_cvt_pk_bf16_f32 v77, v50, v51
    v_cvt_pk_bf16_f32 v78, v52, v53
    v_cvt_pk_bf16_f32 v79, v54, v55
    s_waitcnt lgkmcnt(0)
    v_mfma_f32_32x32x16_bf16 v[40:55], v[16:19], v[8:11], v[88:103]
    ds_read_b128 v[20:23], v1 offset:58368
    s_mov_b64 exec, s[86:87]
    ds_read_b128 v[32:35], v2 offset:56320
    ds_read_b128 v[36:39], v2 offset:56832
    s_mov_b64 exec, -1
    v_exp_f32 v56, v56
    v_exp_f32 v57, v57
    v_exp_f32 v58, v58
    v_exp_f32 v59, v59
    v_exp_f32 v60, v60
    v_mfma_f32_32x32x16_bf16 v[104:119], v[24:27], v[72:75], v[104:119]
    v_exp_f32 v61, v61
    v_exp_f32 v62, v62
    v_exp_f32 v63, v63
    v_exp_f32 v64, v64
    v_exp_f32 v65, v65
    v_mfma_f32_32x32x16_bf16 v[104:119], v[28:31], v[76:79], v[104:119]
    buffer_load_dwordx4 v[236:239], v3, s[32:35], s13 offen offset:1024
    v_exp_f32 v66, v66
    v_exp_f32 v67, v67
    v_exp_f32 v68, v68
    v_exp_f32 v69, v69
    v_exp_f32 v70, v70
    v_exp_f32 v71, v71
    v_cvt_pk_bf16_f32 v80, v56, v57
    v_cvt_pk_bf16_f32 v81, v58, v59
    v_cvt_pk_bf16_f32 v82, v60, v61
    v_cvt_pk_bf16_f32 v83, v62, v63
    v_cvt_pk_bf16_f32 v84, v64, v65
    v_cvt_pk_bf16_f32 v85, v66, v67
    v_cvt_pk_bf16_f32 v86, v68, v69
    v_cvt_pk_bf16_f32 v87, v70, v71
    s_waitcnt lgkmcnt(0)
    v_mfma_f32_32x32x16_bf16 v[56:71], v[20:23], v[8:11], v[88:103]
    ds_read_b128 v[16:19], v1 offset:59392
    s_mov_b64 exec, s[86:87]
    ds_read_b128 v[24:27], v2 offset:57344
    ds_read_b128 v[28:31], v2 offset:57856
    s_mov_b64 exec, -1
    v_exp_f32 v40, v40
    v_exp_f32 v41, v41
    v_exp_f32 v42, v42
    v_exp_f32 v43, v43
    v_exp_f32 v44, v44
    v_mfma_f32_32x32x16_bf16 v[104:119], v[32:35], v[80:83], v[104:119]
    v_exp_f32 v45, v45
    v_exp_f32 v46, v46
    v_exp_f32 v47, v47
    v_exp_f32 v48, v48
    v_exp_f32 v49, v49
    v_mfma_f32_32x32x16_bf16 v[104:119], v[36:39], v[84:87], v[104:119]
    v_exp_f32 v50, v50
    v_exp_f32 v51, v51
    v_exp_f32 v52, v52
    v_exp_f32 v53, v53
    v_exp_f32 v54, v54
    v_exp_f32 v55, v55
    v_cvt_pk_bf16_f32 v72, v40, v41
    v_cvt_pk_bf16_f32 v73, v42, v43
    v_cvt_pk_bf16_f32 v74, v44, v45
    v_cvt_pk_bf16_f32 v75, v46, v47
    v_cvt_pk_bf16_f32 v76, v48, v49
    v_cvt_pk_bf16_f32 v77, v50, v51
    v_cvt_pk_bf16_f32 v78, v52, v53
    v_cvt_pk_bf16_f32 v79, v54, v55
    s_waitcnt lgkmcnt(0)
    v_mfma_f32_32x32x16_bf16 v[40:55], v[16:19], v[8:11], v[88:103]
    ds_read_b128 v[20:23], v1 offset:60416
    s_mov_b64 exec, s[86:87]
    ds_read_b128 v[32:35], v2 offset:58368
    ds_read_b128 v[36:39], v2 offset:58880
    s_mov_b64 exec, -1
    v_exp_f32 v56, v56
    v_exp_f32 v57, v57
    v_exp_f32 v58, v58
    v_exp_f32 v59, v59
    v_exp_f32 v60, v60
    v_mfma_f32_32x32x16_bf16 v[104:119], v[24:27], v[72:75], v[104:119]
    v_exp_f32 v61, v61
    v_exp_f32 v62, v62
    v_exp_f32 v63, v63
    v_exp_f32 v64, v64
    v_exp_f32 v65, v65
    v_mfma_f32_32x32x16_bf16 v[104:119], v[28:31], v[76:79], v[104:119]
    buffer_load_dwordx4 v[240:243], v3, s[32:35], s13 offen offset:2048
    v_exp_f32 v66, v66
    v_exp_f32 v67, v67
    v_exp_f32 v68, v68
    v_exp_f32 v69, v69
    v_exp_f32 v70, v70
    v_exp_f32 v71, v71
    v_cvt_pk_bf16_f32 v80, v56, v57
    v_cvt_pk_bf16_f32 v81, v58, v59
    v_cvt_pk_bf16_f32 v82, v60, v61
    v_cvt_pk_bf16_f32 v83, v62, v63
    v_cvt_pk_bf16_f32 v84, v64, v65
    v_cvt_pk_bf16_f32 v85, v66, v67
    v_cvt_pk_bf16_f32 v86, v68, v69
    v_cvt_pk_bf16_f32 v87, v70, v71
    s_waitcnt lgkmcnt(0)
    v_mfma_f32_32x32x16_bf16 v[56:71], v[20:23], v[8:11], v[88:103]
    ds_read_b128 v[16:19], v1 offset:61440
    s_mov_b64 exec, s[86:87]
    ds_read_b128 v[24:27], v2 offset:59392
    ds_read_b128 v[28:31], v2 offset:59904
    s_mov_b64 exec, -1
    v_exp_f32 v40, v40
    v_exp_f32 v41, v41
    v_exp_f32 v42, v42
    v_exp_f32 v43, v43
    v_exp_f32 v44, v44
    v_mfma_f32_32x32x16_bf16 v[104:119], v[32:35], v[80:83], v[104:119]
    v_exp_f32 v45, v45
    v_exp_f32 v46, v46
    v_exp_f32 v47, v47
    v_exp_f32 v48, v48
    v_exp_f32 v49, v49
    v_mfma_f32_32x32x16_bf16 v[104:119], v[36:39], v[84:87], v[104:119]
    v_exp_f32 v50, v50
    v_exp_f32 v51, v51
    v_exp_f32 v52, v52
    v_exp_f32 v53, v53
    v_exp_f32 v54, v54
    v_exp_f32 v55, v55
    v_cvt_pk_bf16_f32 v72, v40, v41
    v_cvt_pk_bf16_f32 v73, v42, v43
    v_cvt_pk_bf16_f32 v74, v44, v45
    v_cvt_pk_bf16_f32 v75, v46, v47
    v_cvt_pk_bf16_f32 v76, v48, v49
    v_cvt_pk_bf16_f32 v77, v50, v51
    v_cvt_pk_bf16_f32 v78, v52, v53
    v_cvt_pk_bf16_f32 v79, v54, v55
    s_waitcnt lgkmcnt(0)
    v_mfma_f32_32x32x16_bf16 v[40:55], v[16:19], v[8:11], v[88:103]
    ds_read_b128 v[20:23], v1 offset:62464
    s_mov_b64 exec, s[86:87]
    ds_read_b128 v[32:35], v2 offset:60416
    ds_read_b128 v[36:39], v2 offset:60928
    s_mov_b64 exec, -1
    v_exp_f32 v56, v56
    v_exp_f32 v57, v57
    v_exp_f32 v58, v58
    v_exp_f32 v59, v59
    v_exp_f32 v60, v60
    v_mfma_f32_32x32x16_bf16 v[104:119], v[24:27], v[72:75], v[104:119]
    v_exp_f32 v61, v61
    v_exp_f32 v62, v62
    v_exp_f32 v63, v63
    v_exp_f32 v64, v64
    v_exp_f32 v65, v65
    v_mfma_f32_32x32x16_bf16 v[104:119], v[28:31], v[76:79], v[104:119]
    buffer_load_dwordx4 v[244:247], v3, s[32:35], s13 offen offset:3072
    v_exp_f32 v66, v66
    v_exp_f32 v67, v67
    v_exp_f32 v68, v68
    v_exp_f32 v69, v69
    v_exp_f32 v70, v70
    v_exp_f32 v71, v71
    v_cvt_pk_bf16_f32 v80, v56, v57
    v_cvt_pk_bf16_f32 v81, v58, v59
    v_cvt_pk_bf16_f32 v82, v60, v61
    v_cvt_pk_bf16_f32 v83, v62, v63
    v_cvt_pk_bf16_f32 v84, v64, v65
    v_cvt_pk_bf16_f32 v85, v66, v67
    v_cvt_pk_bf16_f32 v86, v68, v69
    v_cvt_pk_bf16_f32 v87, v70, v71
    s_waitcnt lgkmcnt(0)
    v_mfma_f32_32x32x16_bf16 v[56:71], v[20:23], v[8:11], v[88:103]
    ds_read_b128 v[16:19], v1 offset:63488
    s_mov_b64 exec, s[86:87]
    ds_read_b128 v[24:27], v2 offset:61440
    ds_read_b128 v[28:31], v2 offset:61952
    s_mov_b64 exec, -1
    v_exp_f32 v40, v40
    v_exp_f32 v41, v41
    v_exp_f32 v42, v42
    v_exp_f32 v43, v43
    v_exp_f32 v44, v44
    v_mfma_f32_32x32x16_bf16 v[104:119], v[32:35], v[80:83], v[104:119]
    v_exp_f32 v45, v45
    v_exp_f32 v46, v46
    v_exp_f32 v47, v47
    v_exp_f32 v48, v48
    v_exp_f32 v49, v49
    v_mfma_f32_32x32x16_bf16 v[104:119], v[36:39], v[84:87], v[104:119]
    v_exp_f32 v50, v50
    v_exp_f32 v51, v51
    v_exp_f32 v52, v52
    v_exp_f32 v53, v53
    v_exp_f32 v54, v54
    v_exp_f32 v55, v55
    v_cvt_pk_bf16_f32 v72, v40, v41
    v_cvt_pk_bf16_f32 v73, v42, v43
    v_cvt_pk_bf16_f32 v74, v44, v45
    v_cvt_pk_bf16_f32 v75, v46, v47
    v_cvt_pk_bf16_f32 v76, v48, v49
    v_cvt_pk_bf16_f32 v77, v50, v51
    v_cvt_pk_bf16_f32 v78, v52, v53
    v_cvt_pk_bf16_f32 v79, v54, v55
    s_waitcnt lgkmcnt(0)
    v_mfma_f32_32x32x16_bf16 v[40:55], v[16:19], v[8:11], v[88:103]
    ds_read_b128 v[20:23], v1 offset:64512
    s_mov_b64 exec, s[86:87]
    ds_read_b128 v[32:35], v2 offset:62464
    ds_read_b128 v[36:39], v2 offset:62976
    s_mov_b64 exec, -1
    v_exp_f32 v56, v56
    v_exp_f32 v57, v57
    v_exp_f32 v58, v58
    v_exp_f32 v59, v59
    v_exp_f32 v60, v60
    v_mfma_f32_32x32x16_bf16 v[104:119], v[24:27], v[72:75], v[104:119]
    v_exp_f32 v61, v61
    v_exp_f32 v62, v62
    v_exp_f32 v63, v63
    v_exp_f32 v64, v64
    v_exp_f32 v65, v65
    v_mfma_f32_32x32x16_bf16 v[104:119], v[28:31], v[76:79], v[104:119]
    s_add_u32 s13, s13, 4096
    buffer_load_dwordx4 v[248:251], v3, s[32:35], s13 offen offset:0
    v_exp_f32 v66, v66
    v_exp_f32 v67, v67
    v_exp_f32 v68, v68
    v_exp_f32 v69, v69
    v_exp_f32 v70, v70
    v_exp_f32 v71, v71
    v_cvt_pk_bf16_f32 v80, v56, v57
    v_cvt_pk_bf16_f32 v81, v58, v59
    v_cvt_pk_bf16_f32 v82, v60, v61
    v_cvt_pk_bf16_f32 v83, v62, v63
    v_cvt_pk_bf16_f32 v84, v64, v65
    v_cvt_pk_bf16_f32 v85, v66, v67
    v_cvt_pk_bf16_f32 v86, v68, v69
    v_cvt_pk_bf16_f32 v87, v70, v71
    s_waitcnt lgkmcnt(0)
    v_mfma_f32_32x32x16_bf16 v[56:71], v[20:23], v[8:11], v[88:103]
    s_mov_b64 exec, s[86:87]
    ds_read_b128 v[24:27], v2 offset:63488
    ds_read_b128 v[28:31], v2 offset:64000
    s_mov_b64 exec, -1
    v_exp_f32 v40, v40
    v_exp_f32 v41, v41
    v_exp_f32 v42, v42
    v_exp_f32 v43, v43
    v_exp_f32 v44, v44
    v_mfma_f32_32x32x16_bf16 v[104:119], v[32:35], v[80:83], v[104:119]
    v_exp_f32 v45, v45
    v_exp_f32 v46, v46
    v_exp_f32 v47, v47
    v_exp_f32 v48, v48
    v_exp_f32 v49, v49
    v_mfma_f32_32x32x16_bf16 v[104:119], v[36:39], v[84:87], v[104:119]
    v_exp_f32 v50, v50
    v_exp_f32 v51, v51
    v_exp_f32 v52, v52
    v_exp_f32 v53, v53
    v_exp_f32 v54, v54
    v_exp_f32 v55, v55
    v_cvt_pk_bf16_f32 v72, v40, v41
    v_cvt_pk_bf16_f32 v73, v42, v43
    v_cvt_pk_bf16_f32 v74, v44, v45
    v_cvt_pk_bf16_f32 v75, v46, v47
    v_cvt_pk_bf16_f32 v76, v48, v49
    v_cvt_pk_bf16_f32 v77, v50, v51
    v_cvt_pk_bf16_f32 v78, v52, v53
    v_cvt_pk_bf16_f32 v79, v54, v55
    s_waitcnt lgkmcnt(0)
    s_mov_b64 exec, s[86:87]
    ds_read_b128 v[32:35], v2 offset:64512
    ds_read_b128 v[36:39], v2 offset:65024
    s_mov_b64 exec, -1
    v_exp_f32 v56, v56
    v_exp_f32 v57, v57
    v_exp_f32 v58, v58
    v_exp_f32 v59, v59
    v_exp_f32 v60, v60
    v_mfma_f32_32x32x16_bf16 v[104:119], v[24:27], v[72:75], v[104:119]
    v_exp_f32 v61, v61
    v_exp_f32 v62, v62
    v_exp_f32 v63, v63
    v_exp_f32 v64, v64
    v_exp_f32 v65, v65
    v_mfma_f32_32x32x16_bf16 v[104:119], v[28:31], v[76:79], v[104:119]
    buffer_load_dwordx4 v[252:255], v3, s[32:35], s13 offen offset:1024
    v_exp_f32 v66, v66
    v_exp_f32 v67, v67
    v_exp_f32 v68, v68
    v_exp_f32 v69, v69
    v_exp_f32 v70, v70
    v_exp_f32 v71, v71
    v_cvt_pk_bf16_f32 v80, v56, v57
    v_cvt_pk_bf16_f32 v81, v58, v59
    v_cvt_pk_bf16_f32 v82, v60, v61
    v_cvt_pk_bf16_f32 v83, v62, v63
    v_cvt_pk_bf16_f32 v84, v64, v65
    v_cvt_pk_bf16_f32 v85, v66, v67
    v_cvt_pk_bf16_f32 v86, v68, v69
    v_cvt_pk_bf16_f32 v87, v70, v71
    s_waitcnt lgkmcnt(0)
    v_mfma_f32_32x32x16_bf16 v[104:119], v[32:35], v[80:83], v[104:119]
    v_mfma_f32_32x32x16_bf16 v[104:119], v[36:39], v[84:87], v[104:119]
    s_lshl_b32 s88, s84, 16
    s_mov_b32 s89, 34816
    s_add_u32 s89, s89, s88
    buffer_load_dwordx4 v[16:19], v3, s[32:35], s89 offen
    s_mov_b32 s89, 35840
    s_add_u32 s89, s89, s88
    buffer_load_dwordx4 v[20:23], v3, s[32:35], s89 offen
    s_mov_b32 s89, 36864
    s_add_u32 s89, s89, s88
    buffer_load_dwordx4 v[24:27], v3, s[32:35], s89 offen
    s_mov_b32 s89, 37888
    s_add_u32 s89, s89, s88
    buffer_load_dwordx4 v[28:31], v3, s[32:35], s89 offen
    s_mov_b32 s89, 38912
    s_add_u32 s89, s89, s88
    buffer_load_dwordx4 v[32:35], v3, s[32:35], s89 offen
    s_mov_b32 s89, 39936
    s_add_u32 s89, s89, s88
    buffer_load_dwordx4 v[36:39], v3, s[32:35], s89 offen
    s_mov_b32 s89, 40960
    s_add_u32 s89, s89, s88
    buffer_load_dwordx4 v[40:43], v3, s[32:35], s89 offen
    s_mov_b32 s89, 41984
    s_add_u32 s89, s89, s88
    buffer_load_dwordx4 v[44:47], v3, s[32:35], s89 offen
    s_mov_b32 s89, 43008
    s_add_u32 s89, s89, s88
    buffer_load_dwordx4 v[48:51], v3, s[32:35], s89 offen
    s_mov_b32 s89, 44032
    s_add_u32 s89, s89, s88
    buffer_load_dwordx4 v[52:55], v3, s[32:35], s89 offen
    s_mov_b32 s89, 45056
    s_add_u32 s89, s89, s88
    buffer_load_dwordx4 v[56:59], v3, s[32:35], s89 offen
    s_mov_b32 s89, 46080
    s_add_u32 s89, s89, s88
    buffer_load_dwordx4 v[60:63], v3, s[32:35], s89 offen
    s_mov_b32 s89, 47104
    s_add_u32 s89, s89, s88
    buffer_load_dwordx4 v[64:67], v3, s[32:35], s89 offen
    s_mov_b32 s89, 48128
    s_add_u32 s89, s89, s88
    buffer_load_dwordx4 v[68:71], v3, s[32:35], s89 offen
    v_and_b32 v12, 7, v4
    v_lshrrev_b32 v13, 4, v4
    v_lshlrev_b32 v1, 10, v12
    v_lshl_add_u32 v1, v13, 3, v1
    v_lshl_add_u32 v1, v5, 7, v1
    s_lshl_b32 s15, s2, 13
    buffer_load_dwordx2 v[88:89], v1, s[68:71], s15 offen offset:0
    buffer_load_dwordx2 v[96:97], v1, s[28:31], s15 offen offset:0
    buffer_load_dwordx2 v[90:91], v1, s[68:71], s15 offen offset:32
    buffer_load_dwordx2 v[98:99], v1, s[28:31], s15 offen offset:32
    buffer_load_dwordx2 v[92:93], v1, s[68:71], s15 offen offset:64
    buffer_load_dwordx2 v[100:101], v1, s[28:31], s15 offen offset:64
    buffer_load_dwordx2 v[94:95], v1, s[68:71], s15 offen offset:96
    buffer_load_dwordx2 v[102:103], v1, s[28:31], s15 offen offset:96
    v_lshlrev_b32 v2, 2, v6
    ds_bpermute_b32 v14, v2, v112
    v_mul_u32_u24 v2, 1040, v5
    v_lshl_add_u32 v2, v6, 5, v2
    v_lshl_add_u32 v2, v7, 3, v2
    s_waitcnt lgkmcnt(0)
    v_rcp_f32 v14, v14
    s_nop 1
    v_mul_f32 v104, v104, v14
    v_mul_f32 v105, v105, v14
    v_mul_f32 v106, v106, v14
    v_mul_f32 v107, v107, v14
    v_mul_f32 v108, v108, v14
    v_mul_f32 v109, v109, v14
    v_mul_f32 v110, v110, v14
    v_mul_f32 v111, v111, v14
    v_cvt_pk_bf16_f32 v8, v104, v105
    v_cvt_pk_bf16_f32 v9, v106, v107
    v_cvt_pk_bf16_f32 v10, v108, v109
    v_cvt_pk_bf16_f32 v11, v110, v111
    ds_write_b64 v2, v[8:9] offset:0
    ds_write_b64 v2, v[10:11] offset:16
    v_mul_u32_u24 v2, 1040, v12
    v_lshl_add_u32 v2, v13, 4, v2
    v_mov_b32 v72, 0
    v_mov_b32 v73, 0
    v_mov_b32 v74, 0
    v_mov_b32 v75, 0
    v_mov_b32 v76, 0
    v_mov_b32 v77, 0
    v_mov_b32 v78, 0
    v_mov_b32 v79, 0
    v_mov_b32 v80, 0
    v_mov_b32 v81, 0
    v_mov_b32 v82, 0
    v_mov_b32 v83, 0
    v_mov_b32 v84, 0
    v_mov_b32 v85, 0
    v_mov_b32 v86, 0
    v_mov_b32 v87, 0
    s_waitcnt lgkmcnt(0)
    s_barrier
    ds_read_b128 v[104:107], v2 offset:0
    ds_read_b128 v[108:111], v2 offset:64
    ds_read_b128 v[112:115], v2 offset:128
    s_waitcnt vmcnt(22)
    ds_read_b128 v[116:119], v2 offset:192
    s_waitcnt lgkmcnt(3)
    v_mfma_f32_16x16x32_bf16 v[72:75], v[120:123], v[104:107], v[72:75]
    v_mfma_f32_16x16x32_bf16 v[76:79], v[124:127], v[104:107], v[76:79]
    v_mfma_f32_16x16x32_bf16 v[80:83], v[128:131], v[104:107], v[80:83]
    v_mfma_f32_16x16x32_bf16 v[84:87], v[132:135], v[104:107], v[84:87]
    s_mov_b32 s89, 49152
    s_add_u32 s89, s89, s88
    buffer_load_dwordx4 v[120:123], v3, s[32:35], s89 offen
    s_mov_b32 s89, 50176
    s_add_u32 s89, s89, s88
    buffer_load_dwordx4 v[124:127], v3, s[32:35], s89 offen
    s_mov_b32 s89, 51200
    s_add_u32 s89, s89, s88
    buffer_load_dwordx4 v[128:131], v3, s[32:35], s89 offen
    s_mov_b32 s89, 52224
    s_add_u32 s89, s89, s88
    buffer_load_dwordx4 v[132:135], v3, s[32:35], s89 offen
    ds_read_b128 v[104:107], v2 offset:256
    s_waitcnt lgkmcnt(3)
    v_mfma_f32_16x16x32_bf16 v[72:75], v[136:139], v[108:111], v[72:75]
    v_mfma_f32_16x16x32_bf16 v[76:79], v[140:143], v[108:111], v[76:79]
    v_mfma_f32_16x16x32_bf16 v[80:83], v[144:147], v[108:111], v[80:83]
    v_mfma_f32_16x16x32_bf16 v[84:87], v[148:151], v[108:111], v[84:87]
    s_mov_b32 s89, 53248
    s_add_u32 s89, s89, s88
    buffer_load_dwordx4 v[136:139], v3, s[32:35], s89 offen
    s_mov_b32 s89, 54272
    s_add_u32 s89, s89, s88
    buffer_load_dwordx4 v[140:143], v3, s[32:35], s89 offen
    s_mov_b32 s89, 55296
    s_add_u32 s89, s89, s88
    buffer_load_dwordx4 v[144:147], v3, s[32:35], s89 offen
    s_mov_b32 s89, 56320
    s_add_u32 s89, s89, s88
    buffer_load_dwordx4 v[148:151], v3, s[32:35], s89 offen
    ds_read_b128 v[108:111], v2 offset:320
    s_waitcnt lgkmcnt(3)
    v_mfma_f32_16x16x32_bf16 v[72:75], v[152:155], v[112:115], v[72:75]
    v_mfma_f32_16x16x32_bf16 v[76:79], v[156:159], v[112:115], v[76:79]
    v_mfma_f32_16x16x32_bf16 v[80:83], v[160:163], v[112:115], v[80:83]
    v_mfma_f32_16x16x32_bf16 v[84:87], v[164:167], v[112:115], v[84:87]
    s_mov_b32 s89, 57344
    s_add_u32 s89, s89, s88
    buffer_load_dwordx4 v[152:155], v3, s[32:35], s89 offen
    s_mov_b32 s89, 58368
    s_add_u32 s89, s89, s88
    buffer_load_dwordx4 v[156:159], v3, s[32:35], s89 offen
    s_mov_b32 s89, 59392
    s_add_u32 s89, s89, s88
    buffer_load_dwordx4 v[160:163], v3, s[32:35], s89 offen
    s_mov_b32 s89, 60416
    s_add_u32 s89, s89, s88
    buffer_load_dwordx4 v[164:167], v3, s[32:35], s89 offen
    ds_read_b128 v[112:115], v2 offset:384
    s_waitcnt lgkmcnt(3)
    v_mfma_f32_16x16x32_bf16 v[72:75], v[168:171], v[116:119], v[72:75]
    v_mfma_f32_16x16x32_bf16 v[76:79], v[172:175], v[116:119], v[76:79]
    v_mfma_f32_16x16x32_bf16 v[80:83], v[176:179], v[116:119], v[80:83]
    v_mfma_f32_16x16x32_bf16 v[84:87], v[180:183], v[116:119], v[84:87]
    s_mov_b32 s89, 61440
    s_add_u32 s89, s89, s88
    buffer_load_dwordx4 v[168:171], v3, s[32:35], s89 offen
    s_mov_b32 s89, 62464
    s_add_u32 s89, s89, s88
    buffer_load_dwordx4 v[172:175], v3, s[32:35], s89 offen
    s_mov_b32 s89, 63488
    s_add_u32 s89, s89, s88
    buffer_load_dwordx4 v[176:179], v3, s[32:35], s89 offen
    s_mov_b32 s89, 64512
    s_add_u32 s89, s89, s88
    buffer_load_dwordx4 v[180:183], v3, s[32:35], s89 offen
    ds_read_b128 v[116:119], v2 offset:448
    s_waitcnt lgkmcnt(3)
    v_mfma_f32_16x16x32_bf16 v[72:75], v[184:187], v[104:107], v[72:75]
    v_mfma_f32_16x16x32_bf16 v[76:79], v[188:191], v[104:107], v[76:79]
    v_mfma_f32_16x16x32_bf16 v[80:83], v[192:195], v[104:107], v[80:83]
    v_mfma_f32_16x16x32_bf16 v[84:87], v[196:199], v[104:107], v[84:87]
    ds_read_b128 v[104:107], v2 offset:512
    s_waitcnt lgkmcnt(3)
    v_mfma_f32_16x16x32_bf16 v[72:75], v[200:203], v[108:111], v[72:75]
    v_mfma_f32_16x16x32_bf16 v[76:79], v[204:207], v[108:111], v[76:79]
    v_mfma_f32_16x16x32_bf16 v[80:83], v[208:211], v[108:111], v[80:83]
    v_mfma_f32_16x16x32_bf16 v[84:87], v[212:215], v[108:111], v[84:87]
    ds_read_b128 v[108:111], v2 offset:576
    s_waitcnt lgkmcnt(3)
    v_mfma_f32_16x16x32_bf16 v[72:75], v[216:219], v[112:115], v[72:75]
    v_mfma_f32_16x16x32_bf16 v[76:79], v[220:223], v[112:115], v[76:79]
    v_mfma_f32_16x16x32_bf16 v[80:83], v[224:227], v[112:115], v[80:83]
    v_mfma_f32_16x16x32_bf16 v[84:87], v[228:231], v[112:115], v[84:87]
    ds_read_b128 v[112:115], v2 offset:640
    s_waitcnt lgkmcnt(3)
    v_mfma_f32_16x16x32_bf16 v[72:75], v[232:235], v[116:119], v[72:75]
    v_mfma_f32_16x16x32_bf16 v[76:79], v[236:239], v[116:119], v[76:79]
    v_mfma_f32_16x16x32_bf16 v[80:83], v[240:243], v[116:119], v[80:83]
    v_mfma_f32_16x16x32_bf16 v[84:87], v[244:247], v[116:119], v[84:87]
    s_lshr_b32 s92, s90, 3
    s_lshr_b32 s93, s91, 3
    s_cmp_eq_u32 s92, s2
    s_cbranch_scc1 K2_OWN
    s_cmp_lg_u32 s93, s2
    s_cbranch_scc1 K2_NOOWN
K2_OWN:
    s_mov_b32 s95, 0
    v_mov_b32 v12, 128
K2_POLL2:
    v_mov_b32 v13, 0
    s_mov_b64 exec, 1
    buffer_atomic_add v13, v12, s[80:83], 0 offen sc0 sc1
    s_mov_b64 exec, -1
    s_waitcnt vmcnt(0)
    s_nop 1
    v_readfirstlane_b32 s92, v13
    s_cmp_ge_u32 s92, 32
    s_cbranch_scc1 K2_POLL2_OK
    s_sleep 8
    s_add_u32 s95, s95, 1
    s_cmp_lt_u32 s95, 0x100000
    s_cbranch_scc1 K2_POLL2
K2_POLL2_OK:
    v_and_b32 v12, 7, v4
    s_lshl_b32 s92, s2, 3
    v_add_u32 v12, s92, v12
    v_lshlrev_b32 v13, 2, v12
    buffer_load_dword v14, v13, s[72:75], 0 offen
    v_cmp_eq_u32 s[92:93], s91, v12
    v_mov_b32 v13, 0
    v_mov_b32 v15, 2048
    s_nop 1
    v_cndmask_b32 v13, v13, v15, s[92:93]
    v_cmp_eq_u32 vcc, s90, v12
    s_or_b64 s[92:93], s[92:93], vcc
    v_lshrrev_b32 v15, 4, v4
    v_lshl_add_u32 v13, v15, 4, v13
    v_lshl_add_u32 v13, v5, 8, v13
    v_mov_b32 v184, 0
    v_mov_b32 v185, 0
    v_mov_b32 v186, 0
    v_mov_b32 v187, 0
    v_mov_b32 v188, 0
    v_mov_b32 v189, 0
    v_mov_b32 v190, 0
    v_mov_b32 v191, 0
    v_mov_b32 v192, 0
    v_mov_b32 v193, 0
    v_mov_b32 v194, 0
    v_mov_b32 v195, 0
    v_mov_b32 v196, 0
    v_mov_b32 v197, 0
    v_mov_b32 v198, 0
    v_mov_b32 v199, 0
    s_mov_b64 exec, s[92:93]
    buffer_load_dwordx4 v[184:187], v13, s[76:79], 0 offen offset:0 sc1
    buffer_load_dwordx4 v[188:191], v13, s[76:79], 0 offen offset:64 sc1
    buffer_load_dwordx4 v[192:195], v13, s[76:79], 0 offen offset:128 sc1
    buffer_load_dwordx4 v[196:199], v13, s[76:79], 0 offen offset:192 sc1
    s_mov_b64 exec, -1
    s_waitcnt vmcnt(0)
    v_mul_f32 v14, 0xbfb8aa3b, v14
    v_exp_f32 v14, v14
    s_nop 1
    v_add_f32 v14, 1.0, v14
    v_rcp_f32 v14, v14
    s_nop 1
    v_cvt_pk_bf16_f32 v14, 0, v14
    v_cvt_pk_bf16_f32 v184, 0, v184
    v_cvt_pk_bf16_f32 v185, 0, v185
    v_mul_f32 v184, v14, v184
    v_mul_f32 v185, v14, v185
    v_cvt_pk_bf16_f32 v184, 0, v184
    v_cvt_pk_bf16_f32 v185, 0, v185
    v_lshlrev_b32 v12, 16, v96
    v_and_b32 v13, 0xffff0000, v96
    v_add_f32 v12, v12, v184
    v_add_f32 v13, v13, v185
    v_cvt_pk_bf16_f32 v96, v12, v13
    v_cvt_pk_bf16_f32 v186, 0, v186
    v_cvt_pk_bf16_f32 v187, 0, v187
    v_mul_f32 v186, v14, v186
    v_mul_f32 v187, v14, v187
    v_cvt_pk_bf16_f32 v186, 0, v186
    v_cvt_pk_bf16_f32 v187, 0, v187
    v_lshlrev_b32 v12, 16, v97
    v_and_b32 v13, 0xffff0000, v97
    v_add_f32 v12, v12, v186
    v_add_f32 v13, v13, v187
    v_cvt_pk_bf16_f32 v97, v12, v13
    v_cvt_pk_bf16_f32 v188, 0, v188
    v_cvt_pk_bf16_f32 v189, 0, v189
    v_mul_f32 v188, v14, v188
    v_mul_f32 v189, v14, v189
    v_cvt_pk_bf16_f32 v188, 0, v188
    v_cvt_pk_bf16_f32 v189, 0, v189
    v_lshlrev_b32 v12, 16, v98
    v_and_b32 v13, 0xffff0000, v98
    v_add_f32 v12, v12, v188
    v_add_f32 v13, v13, v189
    v_cvt_pk_bf16_f32 v98, v12, v13
    v_cvt_pk_bf16_f32 v190, 0, v190
    v_cvt_pk_bf16_f32 v191, 0, v191
    v_mul_f32 v190, v14, v190
    v_mul_f32 v191, v14, v191
    v_cvt_pk_bf16_f32 v190, 0, v190
    v_cvt_pk_bf16_f32 v191, 0, v191
    v_lshlrev_b32 v12, 16, v99
    v_and_b32 v13, 0xffff0000, v99
    v_add_f32 v12, v12, v190
    v_add_f32 v13, v13, v191
    v_cvt_pk_bf16_f32 v99, v12, v13
    v_cvt_pk_bf16_f32 v192, 0, v192
    v_cvt_pk_bf16_f32 v193, 0, v193
    v_mul_f32 v192, v14, v192
    v_mul_f32 v193, v14, v193
    v_cvt_pk_bf16_f32 v192, 0, v192
    v_cvt_pk_bf16_f32 v193, 0, v193
    v_lshlrev_b32 v12, 16, v100
    v_and_b32 v13, 0xffff0000, v100
    v_add_f32 v12, v12, v192
    v_add_f32 v13, v13, v193
    v_cvt_pk_bf16_f32 v100, v12, v13
    v_cvt_pk_bf16_f32 v194, 0, v194
    v_cvt_pk_bf16_f32 v195, 0, v195
    v_mul_f32 v194, v14, v194
    v_mul_f32 v195, v14, v195
    v_cvt_pk_bf16_f32 v194, 0, v194
    v_cvt_pk_bf16_f32 v195, 0, v195
    v_lshlrev_b32 v12, 16, v101
    v_and_b32 v13, 0xffff0000, v101
    v_add_f32 v12, v12, v194
    v_add_f32 v13, v13, v195
    v_cvt_pk_bf16_f32 v101, v12, v13
    v_cvt_pk_bf16_f32 v196, 0, v196
    v_cvt_pk_bf16_f32 v197, 0, v197
    v_mul_f32 v196, v14, v196
    v_mul_f32 v197, v14, v197
    v_cvt_pk_bf16_f32 v196, 0, v196
    v_cvt_pk_bf16_f32 v197, 0, v197
    v_lshlrev_b32 v12, 16, v102
    v_and_b32 v13, 0xffff0000, v102
    v_add_f32 v12, v12, v196
    v_add_f32 v13, v13, v197
    v_cvt_pk_bf16_f32 v102, v12, v13
    v_cvt_pk_bf16_f32 v198, 0, v198
    v_cvt_pk_bf16_f32 v199, 0, v199
    v_mul_f32 v198, v14, v198
    v_mul_f32 v199, v14, v199
    v_cvt_pk_bf16_f32 v198, 0, v198
    v_cvt_pk_bf16_f32 v199, 0, v199
    v_lshlrev_b32 v12, 16, v103
    v_and_b32 v13, 0xffff0000, v103
    v_add_f32 v12, v12, v198
    v_add_f32 v13, v13, v199
    v_cvt_pk_bf16_f32 v103, v12, v13
K2_NOOWN:
    s_waitcnt vmcnt(36)
    ds_read_b128 v[116:119], v2 offset:704
    s_waitcnt lgkmcnt(3)
    v_mfma_f32_16x16x32_bf16 v[72:75], v[248:251], v[104:107], v[72:75]
    v_mfma_f32_16x16x32_bf16 v[76:79], v[252:255], v[104:107], v[76:79]
    v_mfma_f32_16x16x32_bf16 v[80:83], v[16:19], v[104:107], v[80:83]
    v_mfma_f32_16x16x32_bf16 v[84:87], v[20:23], v[104:107], v[84:87]
    s_waitcnt vmcnt(32)
    ds_read_b128 v[104:107], v2 offset:768
    s_waitcnt lgkmcnt(3)
    v_mfma_f32_16x16x32_bf16 v[72:75], v[24:27], v[108:111], v[72:75]
    v_mfma_f32_16x16x32_bf16 v[76:79], v[28:31], v[108:111], v[76:79]
    v_mfma_f32_16x16x32_bf16 v[80:83], v[32:35], v[108:111], v[80:83]
    v_mfma_f32_16x16x32_bf16 v[84:87], v[36:39], v[108:111], v[84:87]
    s_waitcnt vmcnt(28)
    ds_read_b128 v[108:111], v2 offset:832
    s_waitcnt lgkmcnt(3)
    v_mfma_f32_16x16x32_bf16 v[72:75], v[40:43], v[112:115], v[72:75]
    v_mfma_f32_16x16x32_bf16 v[76:79], v[44:47], v[112:115], v[76:79]
    v_mfma_f32_16x16x32_bf16 v[80:83], v[48:51], v[112:115], v[80:83]
    v_mfma_f32_16x16x32_bf16 v[84:87], v[52:55], v[112:115], v[84:87]
    s_waitcnt vmcnt(24)
    ds_read_b128 v[112:115], v2 offset:896
    s_waitcnt lgkmcnt(3)
    v_mfma_f32_16x16x32_bf16 v[72:75], v[56:59], v[116:119], v[72:75]
    v_mfma_f32_16x16x32_bf16 v[76:79], v[60:63], v[116:119], v[76:79]
    v_mfma_f32_16x16x32_bf16 v[80:83], v[64:67], v[116:119], v[80:83]
    v_mfma_f32_16x16x32_bf16 v[84:87], v[68:71], v[116:119], v[84:87]
    s_waitcnt vmcnt(12)
    ds_read_b128 v[116:119], v2 offset:960
    s_waitcnt lgkmcnt(3)
    v_mfma_f32_16x16x32_bf16 v[72:75], v[120:123], v[104:107], v[72:75]
    v_mfma_f32_16x16x32_bf16 v[76:79], v[124:127], v[104:107], v[76:79]
    v_mfma_f32_16x16x32_bf16 v[80:83], v[128:131], v[104:107], v[80:83]
    v_mfma_f32_16x16x32_bf16 v[84:87], v[132:135], v[104:107], v[84:87]
    s_waitcnt vmcnt(8)
    s_waitcnt lgkmcnt(2)
    v_mfma_f32_16x16x32_bf16 v[72:75], v[136:139], v[108:111], v[72:75]
    v_mfma_f32_16x16x32_bf16 v[76:79], v[140:143], v[108:111], v[76:79]
    v_mfma_f32_16x16x32_bf16 v[80:83], v[144:147], v[108:111], v[80:83]
    v_mfma_f32_16x16x32_bf16 v[84:87], v[148:151], v[108:111], v[84:87]
    s_waitcnt vmcnt(4)
    s_waitcnt lgkmcnt(1)
    v_mfma_f32_16x16x32_bf16 v[72:75], v[152:155], v[112:115], v[72:75]
    v_mfma_f32_16x16x32_bf16 v[76:79], v[156:159], v[112:115], v[76:79]
    v_mfma_f32_16x16x32_bf16 v[80:83], v[160:163], v[112:115], v[80:83]
    v_mfma_f32_16x16x32_bf16 v[84:87], v[164:167], v[112:115], v[84:87]
    s_waitcnt vmcnt(0)
    s_waitcnt lgkmcnt(0)
    v_mfma_f32_16x16x32_bf16 v[72:75], v[168:171], v[116:119], v[72:75]
    v_mfma_f32_16x16x32_bf16 v[76:79], v[172:175], v[116:119], v[76:79]
    v_mfma_f32_16x16x32_bf16 v[80:83], v[176:179], v[116:119], v[80:83]
    v_mfma_f32_16x16x32_bf16 v[84:87], v[180:183], v[116:119], v[84:87]
    s_nop 7
    s_nop 1
    v_lshlrev_b32 v12, 16, v88
    v_and_b32 v13, 0xffff0000, v88
    v_lshlrev_b32 v14, 16, v96
    v_and_b32 v15, 0xffff0000, v96
    v_cvt_pk_bf16_f32 v72, 0, v72
    v_cvt_pk_bf16_f32 v73, 0, v73
    v_add_f32 v12, v12, v72
    v_add_f32 v13, v13, v73
    v_cvt_pk_bf16_f32 v12, 0, v12
    v_cvt_pk_bf16_f32 v13, 0, v13
    v_add_f32 v12, v12, v14
    v_add_f32 v13, v13, v15
    v_cvt_pk_bf16_f32 v16, v12, v13
    v_lshlrev_b32 v12, 16, v89
    v_and_b32 v13, 0xffff0000, v89
    v_lshlrev_b32 v14, 16, v97
    v_and_b32 v15, 0xffff0000, v97
    v_cvt_pk_bf16_f32 v74, 0, v74
    v_cvt_pk_bf16_f32 v75, 0, v75
    v_add_f32 v12, v12, v74
    v_add_f32 v13, v13, v75
    v_cvt_pk_bf16_f32 v12, 0, v12
    v_cvt_pk_bf16_f32 v13, 0, v13
    v_add_f32 v12, v12, v14
    v_add_f32 v13, v13, v15
    v_cvt_pk_bf16_f32 v17, v12, v13
    v_lshlrev_b32 v12, 16, v90
    v_and_b32 v13, 0xffff0000, v90
    v_lshlrev_b32 v14, 16, v98
    v_and_b32 v15, 0xffff0000, v98
    v_cvt_pk_bf16_f32 v76, 0, v76
    v_cvt_pk_bf16_f32 v77, 0, v77
    v_add_f32 v12, v12, v76
    v_add_f32 v13, v13, v77
    v_cvt_pk_bf16_f32 v12, 0, v12
    v_cvt_pk_bf16_f32 v13, 0, v13
    v_add_f32 v12, v12, v14
    v_add_f32 v13, v13, v15
    v_cvt_pk_bf16_f32 v18, v12, v13
    v_lshlrev_b32 v12, 16, v91
    v_and_b32 v13, 0xffff0000, v91
    v_lshlrev_b32 v14, 16, v99
    v_and_b32 v15, 0xffff0000, v99
    v_cvt_pk_bf16_f32 v78, 0, v78
    v_cvt_pk_bf16_f32 v79, 0, v79
    v_add_f32 v12, v12, v78
    v_add_f32 v13, v13, v79
    v_cvt_pk_bf16_f32 v12, 0, v12
    v_cvt_pk_bf16_f32 v13, 0, v13
    v_add_f32 v12, v12, v14
    v_add_f32 v13, v13, v15
    v_cvt_pk_bf16_f32 v19, v12, v13
    v_lshlrev_b32 v12, 16, v92
    v_and_b32 v13, 0xffff0000, v92
    v_lshlrev_b32 v14, 16, v100
    v_and_b32 v15, 0xffff0000, v100
    v_cvt_pk_bf16_f32 v80, 0, v80
    v_cvt_pk_bf16_f32 v81, 0, v81
    v_add_f32 v12, v12, v80
    v_add_f32 v13, v13, v81
    v_cvt_pk_bf16_f32 v12, 0, v12
    v_cvt_pk_bf16_f32 v13, 0, v13
    v_add_f32 v12, v12, v14
    v_add_f32 v13, v13, v15
    v_cvt_pk_bf16_f32 v20, v12, v13
    v_lshlrev_b32 v12, 16, v93
    v_and_b32 v13, 0xffff0000, v93
    v_lshlrev_b32 v14, 16, v101
    v_and_b32 v15, 0xffff0000, v101
    v_cvt_pk_bf16_f32 v82, 0, v82
    v_cvt_pk_bf16_f32 v83, 0, v83
    v_add_f32 v12, v12, v82
    v_add_f32 v13, v13, v83
    v_cvt_pk_bf16_f32 v12, 0, v12
    v_cvt_pk_bf16_f32 v13, 0, v13
    v_add_f32 v12, v12, v14
    v_add_f32 v13, v13, v15
    v_cvt_pk_bf16_f32 v21, v12, v13
    v_lshlrev_b32 v12, 16, v94
    v_and_b32 v13, 0xffff0000, v94
    v_lshlrev_b32 v14, 16, v102
    v_and_b32 v15, 0xffff0000, v102
    v_cvt_pk_bf16_f32 v84, 0, v84
    v_cvt_pk_bf16_f32 v85, 0, v85
    v_add_f32 v12, v12, v84
    v_add_f32 v13, v13, v85
    v_cvt_pk_bf16_f32 v12, 0, v12
    v_cvt_pk_bf16_f32 v13, 0, v13
    v_add_f32 v12, v12, v14
    v_add_f32 v13, v13, v15
    v_cvt_pk_bf16_f32 v22, v12, v13
    v_lshlrev_b32 v12, 16, v95
    v_and_b32 v13, 0xffff0000, v95
    v_lshlrev_b32 v14, 16, v103
    v_and_b32 v15, 0xffff0000, v103
    v_cvt_pk_bf16_f32 v86, 0, v86
    v_cvt_pk_bf16_f32 v87, 0, v87
    v_add_f32 v12, v12, v86
    v_add_f32 v13, v13, v87
    v_cvt_pk_bf16_f32 v12, 0, v12
    v_cvt_pk_bf16_f32 v13, 0, v13
    v_add_f32 v12, v12, v14
    v_add_f32 v13, v13, v15
    v_cvt_pk_bf16_f32 v23, v12, v13
    s_mov_b32 s92, 0x00ff00ff
    s_mov_b32 s93, 0x00ff00ff
    s_mov_b64 exec, s[92:93]
    buffer_store_dwordx2 v[16:17], v1, s[64:67], s15 offen offset:0
    buffer_store_dwordx2 v[18:19], v1, s[64:67], s15 offen offset:32
    buffer_store_dwordx2 v[20:21], v1, s[64:67], s15 offen offset:64
    buffer_store_dwordx2 v[22:23], v1, s[64:67], s15 offen offset:96
    s_mov_b64 exec, -1
    s_branch K2_END
K2_SIG1:
    s_waitcnt vmcnt(0)
    v_mov_b32 v12, 0
    v_mov_b32 v13, 1
    s_mov_b64 exec, 1
    buffer_atomic_add v13, v12, s[80:83], 0 offen sc1
    s_mov_b64 exec, -1
    s_branch K2_SIG1R
K2_SIG2:
    s_waitcnt vmcnt(0)
    v_mov_b32 v12, 128
    v_mov_b32 v13, 1
    s_mov_b64 exec, 1
    buffer_atomic_add v13, v12, s[80:83], 0 offen sc1
    s_mov_b64 exec, -1
    s_branch K2_SIG2R
K2_D0:
    s_mov_b32 s95, 0
    v_mov_b32 v12, 0
K2_POLL1:
    v_mov_b32 v13, 0
    s_mov_b64 exec, 1
    buffer_atomic_add v13, v12, s[80:83], 0 offen sc0 sc1
    s_mov_b64 exec, -1
    s_waitcnt vmcnt(0)
    s_nop 1
    v_readfirstlane_b32 s92, v13
    s_cmp_ge_u32 s92, 172
    s_cbranch_scc1 K2_POLL1_OK
    s_sleep 8
    s_add_u32 s95, s95, 1
    s_cmp_lt_u32 s95, 0x100000
    s_cbranch_scc1 K2_POLL1
K2_POLL1_OK:
    v_cmp_gt_u32 vcc, 172, v0
    v_mov_b32 v12, 5440
    v_mov_b32 v13, 4096
    s_nop 1
    v_cndmask_b32 v12, v12, v13, vcc
    v_lshl_add_u32 v12, v0, 4, v12
    v_cmp_gt_u32 vcc, 344, v0
    s_and_saveexec_b64 s[92:93], vcc
    buffer_load_dwordx4 v[12:15], v12, s[76:79], 0 offen sc1
    s_mov_b64 exec, s[92:93]
    s_branch K2_D0R
K2_D1:
    s_waitcnt vmcnt(0)
    v_cmp_gt_u32 vcc, 172, v0
    v_mov_b32 v228, 17600
    v_mov_b32 v229, 17536
    s_nop 1
    v_cndmask_b32 v228, v228, v229, vcc
    v_lshl_add_u32 v228, v0, 4, v228
    v_cmp_gt_u32 vcc, 344, v0
    s_and_saveexec_b64 s[92:93], vcc
    ds_write_b128 v228, v[12:15]
    s_mov_b64 exec, s[92:93]
    s_waitcnt lgkmcnt(0)
    s_branch K2_D1R
K2_D2:
    v_and_b32 v14, 1, v4
    v_mul_u32_u24 v14, 2816, v14
    v_lshrrev_b32 v13, 4, v4
    v_lshl_add_u32 v14, v13, 4, v14
    v_lshl_add_u32 v14, v5, 6, v14
    v_add_u32 v14, 17536, v14
    s_barrier
    ds_read_b128 v[204:207], v14 offset:0
    ds_read_b128 v[208:211], v14 offset:512
    ds_read_b128 v[212:215], v14 offset:1024
    ds_read_b128 v[216:219], v14 offset:1536
    ds_read_b128 v[220:223], v14 offset:2048
    ds_read_b128 v[224:227], v14 offset:2560
    s_waitcnt lgkmcnt(0)
    v_mfma_f32_16x16x32_bf16 v[228:231], v[232:235], v[204:207], 0
    v_mfma_f32_16x16x32_bf16 v[228:231], v[236:239], v[208:211], v[228:231]
    v_mfma_f32_16x16x32_bf16 v[228:231], v[240:243], v[212:215], v[228:231]
    v_mfma_f32_16x16x32_bf16 v[228:231], v[244:247], v[216:219], v[228:231]
    v_mfma_f32_16x16x32_bf16 v[228:231], v[248:251], v[220:223], v[228:231]
    s_cmp_ge_u32 s84, 3
    s_cbranch_scc1 K2_STD1
    v_mfma_f32_16x16x32_bf16 v[228:231], v[252:255], v[224:227], v[228:231]
K2_STD1:
    v_and_b32 v12, 15, v4
    v_lshrrev_b32 v13, 4, v4
    v_lshlrev_b32 v14, 7, v5
    v_lshl_add_u32 v14, v12, 6, v14
    v_lshl_add_u32 v14, v13, 4, v14
    s_mov_b32 s92, 0x00030003
    s_mov_b32 s93, 0x00030003
    s_nop 3
    s_mov_b64 exec, s[92:93]
    ds_write_b128 v14, v[228:231] offset:16512
    s_mov_b64 exec, -1
    s_waitcnt lgkmcnt(0)
    s_barrier
    s_mov_b32 s94, 0
    s_cmp_lg_u32 s84, 0
    s_cbranch_scc1 K2_D2R
    v_lshlrev_b32 v14, 2, v6
    ds_read_b32 v204, v14 offset:16512
    ds_read_b32 v205, v14 offset:16640
    ds_read_b32 v206, v14 offset:16768
    ds_read_b32 v207, v14 offset:16896
    ds_read_b32 v208, v14 offset:17024
    ds_read_b32 v209, v14 offset:17152
    ds_read_b32 v210, v14 offset:17280
    ds_read_b32 v211, v14 offset:17408
    v_lshrrev_b32 v12, 4, v6
    v_and_b32 v13, 15, v6
    v_lshlrev_b32 v12, 11, v12
    v_lshl_add_u32 v12, v13, 2, v12
    s_sub_u32 s92, s2, 224
    s_lshl_b32 s92, s92, 6
    s_waitcnt lgkmcnt(0)
    v_add_f32 v204, v204, v205
    v_add_f32 v204, v204, v206
    v_add_f32 v204, v204, v207
    v_add_f32 v204, v204, v208
    v_add_f32 v204, v204, v209
    v_add_f32 v204, v204, v210
    v_add_f32 v204, v204, v211
    s_mov_b64 exec, 0xffffffff
    buffer_store_dword v204, v12, s[76:79], s92 offen sc1
    s_mov_b64 exec, -1
    s_mov_b32 s94, 3
    s_branch K2_D2R
K2_END:
    s_endpgm
.section .rodata,"a"
.p2align 6
.amdhsa_kernel k1_kernel
  .amdhsa_next_free_vgpr 240
  .amdhsa_next_free_sgpr 102
  .amdhsa_accum_offset 240
  .amdhsa_group_segment_fixed_size 0
  .amdhsa_kernarg_size 104
  .amdhsa_user_sgpr_count 2
  .amdhsa_user_sgpr_kernarg_segment_ptr 1
  .amdhsa_system_sgpr_workgroup_id_x 1
.end_amdhsa_kernel
.p2align 6
.amdhsa_kernel k2_kernel
  .amdhsa_next_free_vgpr 256
  .amdhsa_next_free_sgpr 102
  .amdhsa_accum_offset 256
  .amdhsa_group_segment_fixed_size 0
  .amdhsa_kernarg_size 104
  .amdhsa_user_sgpr_count 2
  .amdhsa_user_sgpr_kernarg_segment_ptr 1
  .amdhsa_system_sgpr_workgroup_id_x 1
.end_amdhsa_kernel
```
